```python
import torch

def _softmax(x, axis=-1):
    return torch.softmax(x, dim=axis)
def _gelu(x):
    return torch.nn.functional.gelu(x, approximate="tanh")
def _silu(x):
    return torch.nn.functional.silu(x)
def _sigmoid(x):
    return torch.sigmoid(x)
def _layernorm(x, axis=-1, eps=1e-5):
    m = x.mean(dim=axis, keepdim=True)
    v = x.var(dim=axis, keepdim=True, unbiased=False)
    return (x - m) / torch.sqrt(v + eps)
def _scatter_add(tgt, idx, src, axis=0):
    return tgt.clone().index_add_(axis, idx, src)
def _segment_sum(src, seg, n):
    out = torch.zeros((n,) + src.shape[1:], dtype=src.dtype)
    return out.index_add_(0, seg, src)
def _pad(x, pw):
    flat = tuple(v for pair in reversed(pw) for v in pair)
    return torch.nn.functional.pad(x, flat)

kernel_name = 'parallel_sum__grouped_kv_mqa__moe_arch_mod__prompt'

def setup_inputs():

    _w = (lambda a: (lambda t: t.to(torch.bfloat16) if t.is_floating_point() else t)(torch.as_tensor(a)))
    def _A_setup():
        B, S, D, H = 1, 2048, 512, 32
        Dh = D // H
        return {
            "x": _w((lambda *s: torch.randn(*s, dtype=torch.bfloat16) * 0.05)(B, S, D)),
            "wq": _w((lambda *s: torch.randn(*s, dtype=torch.bfloat16) * 0.2)(D, H * Dh)),
            "wk": _w((lambda *s: torch.randn(*s, dtype=torch.bfloat16) * 0.2)(D, Dh)),
            "wv": _w((lambda *s: torch.randn(*s, dtype=torch.bfloat16) * 0.1)(D, Dh)),
            "wo": _w((lambda *s: torch.randn(*s, dtype=torch.bfloat16) * 0.1)(H * Dh, D)),
        }
    _A_in = _A_setup()

    def _B_setup():
        B, S, D, F, C = 1, 2048, 512, 1376, 2
        return {
            "x": _w((lambda *s: torch.randn(*s, dtype=torch.bfloat16) * 0.05)(B, S, D)),
            "w_r": _w((lambda *s: torch.randn(*s, dtype=torch.bfloat16) * 0.2)(D)),
            "w_gate": _w((lambda *s: torch.randn(*s, dtype=torch.bfloat16) * 0.1)(D, F)),
            "w_up": _w((lambda *s: torch.randn(*s, dtype=torch.bfloat16) * 0.1)(D, F)),
            "w_down": _w((lambda *s: torch.randn(*s, dtype=torch.bfloat16) * 0.1)(F, D)),
        }
    _B_in = _B_setup()

    return {
        "A_x": _A_in["x"],
        "A_wq": _A_in["wq"],
        "A_wk": _A_in["wk"],
        "A_wv": _A_in["wv"],
        "A_wo": _A_in["wo"],
        "B_x": _B_in["x"],
        "B_w_r": _B_in["w_r"],
        "B_w_gate": _B_in["w_gate"],
        "B_w_up": _B_in["w_up"],
        "B_w_down": _B_in["w_down"],
    }

def reference(A_x, A_wq, A_wk, A_wv, A_wo, B_x, B_w_r, B_w_gate, B_w_up, B_w_down):
    def _A_ref(x, wq, wk, wv, wo):
        B, S, D = x.shape
        H = 32
        Dh = D // H
        q = (lambda x, *d: x.permute(*d))((x @ wq).reshape(B, S, H, Dh), 0, 2, 1, 3)
        k = x @ wk
        v = x @ wv
        scores = torch.einsum("bhqd,bkd->bhqk", q, k) * (Dh ** -0.5)
        p = _softmax(scores, axis=-1)
        o = torch.einsum("bhqk,bkd->bhqd", p, v)
        return (lambda x, *d: x.permute(*d))(o, 0, 2, 1, 3).reshape(B, S, H * Dh) @ wo

    def _B_ref(x, w_r, w_gate, w_up, w_down):
        B, S, D = x.shape
        C = 2
        r = x @ w_r
        idx = torch.argsort(-r, axis=-1)[:, :C]
        idx_e = (lambda x, n, axis: torch.repeat_interleave(x, n, dim=axis))(idx.reshape(B, C, 1), D, axis=2)
        x_sel = (lambda x, i, axis: torch.take_along_dim(x, i, dim=axis))(x, idx_e, axis=1)
        g = _silu(x_sel @ w_gate)
        u = x_sel @ w_up
        y = (g * u) @ w_down
        r_sel = _sigmoid((lambda x, i, axis: torch.take_along_dim(x, i, dim=axis))(r, idx, axis=1))
        y = y * r_sel.reshape(B, C, 1)
        b_off = (torch.arange(B) * S).reshape(B, 1)
        flat_idx = (idx + b_off).reshape(B * C)
        zero = (x * 0.0).reshape(B * S, D)
        upd = _scatter_add(zero, flat_idx, y.reshape(B * C, D), axis=0)
        return x + upd.reshape(B, S, D)

    x = A_x
    xn = _layernorm(x, axis=-1)
    return x + _A_ref(xn, A_wq, A_wk, A_wv, A_wo) + _B_ref(xn, B_w_r, B_w_gate, B_w_up, B_w_down)
```

```asm
; @launch kernel=prep_kernel grid=(256,1,1) block=(256,1,1) lds=132096
; @launch kernel=attn_kernel grid=(299,1,1) block=(1024,1,1) lds=135168
; @launch kernel=out_kernel grid=(256,1,1) block=(256,1,1) lds=132096
.amdgcn_target "amdgcn-amd-amdhsa--gfx950"
.text
.globl prep_kernel
.p2align 8
.type prep_kernel,@function
prep_kernel:
    s_cmp_ge_u32 s2, 256
    s_cbranch_scc1 K1_END
    s_load_dwordx2 s[4:5], s[0:1], 0
    s_load_dwordx2 s[6:7], s[0:1], 8
    s_load_dwordx4 s[8:11], s[0:1], 16
    s_load_dwordx2 s[12:13], s[0:1], 48
    s_load_dwordx2 s[14:15], s[0:1], 96
    s_and_b32 s20, s2, 31
    s_lshr_b32 s21, s2, 5
    v_and_b32 v1, 63, v0
    v_lshrrev_b32 v2, 6, v0
    s_nop 0
    v_readfirstlane_b32 s22, v2
    s_waitcnt lgkmcnt(0)
    s_mov_b32 s24, s4
    s_and_b32 s25, s5, 0xffff
    s_mov_b32 s26, 0x200000
    s_mov_b32 s27, 0x00020000
    s_mov_b32 s28, s6
    s_and_b32 s29, s7, 0xffff
    s_mov_b32 s30, 0x80000
    s_mov_b32 s31, 0x00020000
    s_mov_b32 s32, s8
    s_and_b32 s33, s9, 0xffff
    s_mov_b32 s34, 0x4000
    s_mov_b32 s35, 0x00020000
    s_mov_b32 s44, s10
    s_and_b32 s45, s11, 0xffff
    s_mov_b32 s46, 0x4000
    s_mov_b32 s47, 0x00020000
    s_mov_b32 s36, s14
    s_and_b32 s37, s15, 0xffff
    s_mov_b32 s38, 0x800000
    s_mov_b32 s39, 0x00020000
    s_mov_b32 s40, s12
    s_and_b32 s41, s13, 0xffff
    s_mov_b32 s42, 0x400
    s_mov_b32 s43, 0x00020000
    s_and_b32 s23, s22, 1
    s_lshr_b32 s19, s22, 1
    s_cmp_lg_u32 s2, 0
    s_cbranch_scc1 K1_NOZ
    s_cmp_lg_u32 s22, 0
    s_cbranch_scc1 K1_NOZ
    v_mov_b32 v4, 0
    v_mov_b32 v5, 0
    v_mov_b32 v6, 0
    v_mov_b32 v7, 0
    v_lshlrev_b32 v2, 4, v1
    v_add_u32 v2, 7340032, v2
    buffer_store_dwordx4 v[4:7], v2, s[36:39], 0 offen offset:0
    buffer_store_dwordx4 v[4:7], v2, s[36:39], 0 offen offset:1024
    buffer_store_dwordx4 v[4:7], v2, s[36:39], 0 offen offset:2048
    buffer_store_dwordx4 v[4:7], v2, s[36:39], 0 offen offset:3072
K1_NOZ:
    s_cmp_eq_u32 s21, 8
    s_cbranch_scc1 K1_STAGE_KV
    v_lshrrev_b32 v2, 3, v1
    v_lshlrev_b32 v2, 10, v2
    v_and_b32 v3, 7, v1
    v_lshlrev_b32 v3, 4, v3
    v_add_u32 v2, v2, v3
    s_lshl_b32 s60, s22, 17
    s_lshl_b32 s61, s21, 7
    s_add_u32 s60, s60, s61
    s_lshl_b32 s61, s22, 14
    s_add_u32 s61, s61, 66560
    s_mov_b32 m0, s61
    s_nop 0
    buffer_load_dwordx4 v2, s[28:31], s60 offen lds
    s_add_u32 s60, s60, 8192
    s_add_u32 s61, s61, 1024
    s_mov_b32 m0, s61
    s_nop 0
    buffer_load_dwordx4 v2, s[28:31], s60 offen lds
    s_add_u32 s60, s60, 8192
    s_add_u32 s61, s61, 1024
    s_mov_b32 m0, s61
    s_nop 0
    buffer_load_dwordx4 v2, s[28:31], s60 offen lds
    s_add_u32 s60, s60, 8192
    s_add_u32 s61, s61, 1024
    s_mov_b32 m0, s61
    s_nop 0
    buffer_load_dwordx4 v2, s[28:31], s60 offen lds
    s_add_u32 s60, s60, 8192
    s_add_u32 s61, s61, 1024
    s_mov_b32 m0, s61
    s_nop 0
    buffer_load_dwordx4 v2, s[28:31], s60 offen lds
    s_add_u32 s60, s60, 8192
    s_add_u32 s61, s61, 1024
    s_mov_b32 m0, s61
    s_nop 0
    buffer_load_dwordx4 v2, s[28:31], s60 offen lds
    s_add_u32 s60, s60, 8192
    s_add_u32 s61, s61, 1024
    s_mov_b32 m0, s61
    s_nop 0
    buffer_load_dwordx4 v2, s[28:31], s60 offen lds
    s_add_u32 s60, s60, 8192
    s_add_u32 s61, s61, 1024
    s_mov_b32 m0, s61
    s_nop 0
    buffer_load_dwordx4 v2, s[28:31], s60 offen lds
    s_add_u32 s60, s60, 8192
    s_add_u32 s61, s61, 1024
    s_mov_b32 m0, s61
    s_nop 0
    buffer_load_dwordx4 v2, s[28:31], s60 offen lds
    s_add_u32 s60, s60, 8192
    s_add_u32 s61, s61, 1024
    s_mov_b32 m0, s61
    s_nop 0
    buffer_load_dwordx4 v2, s[28:31], s60 offen lds
    s_add_u32 s60, s60, 8192
    s_add_u32 s61, s61, 1024
    s_mov_b32 m0, s61
    s_nop 0
    buffer_load_dwordx4 v2, s[28:31], s60 offen lds
    s_add_u32 s60, s60, 8192
    s_add_u32 s61, s61, 1024
    s_mov_b32 m0, s61
    s_nop 0
    buffer_load_dwordx4 v2, s[28:31], s60 offen lds
    s_add_u32 s60, s60, 8192
    s_add_u32 s61, s61, 1024
    s_mov_b32 m0, s61
    s_nop 0
    buffer_load_dwordx4 v2, s[28:31], s60 offen lds
    s_add_u32 s60, s60, 8192
    s_add_u32 s61, s61, 1024
    s_mov_b32 m0, s61
    s_nop 0
    buffer_load_dwordx4 v2, s[28:31], s60 offen lds
    s_add_u32 s60, s60, 8192
    s_add_u32 s61, s61, 1024
    s_mov_b32 m0, s61
    s_nop 0
    buffer_load_dwordx4 v2, s[28:31], s60 offen lds
    s_add_u32 s60, s60, 8192
    s_add_u32 s61, s61, 1024
    s_mov_b32 m0, s61
    s_nop 0
    buffer_load_dwordx4 v2, s[28:31], s60 offen lds
    s_add_u32 s60, s60, 8192
    s_add_u32 s61, s61, 1024
    s_branch K1_STAGED
K1_STAGE_KV:
    v_lshlrev_b32 v2, 4, v1
    s_lshl_b32 s60, s22, 12
    s_add_u32 s61, s60, 66560
    s_mov_b32 m0, s61
    s_nop 0
    buffer_load_dwordx4 v2, s[32:35], s60 offen lds
    s_add_u32 s62, s61, 16384
    s_mov_b32 m0, s62
    s_nop 0
    buffer_load_dwordx4 v2, s[44:47], s60 offen lds
    s_add_u32 s60, s60, 1024
    s_add_u32 s61, s61, 1024
    s_mov_b32 m0, s61
    s_nop 0
    buffer_load_dwordx4 v2, s[32:35], s60 offen lds
    s_add_u32 s62, s61, 16384
    s_mov_b32 m0, s62
    s_nop 0
    buffer_load_dwordx4 v2, s[44:47], s60 offen lds
    s_add_u32 s60, s60, 1024
    s_add_u32 s61, s61, 1024
    s_mov_b32 m0, s61
    s_nop 0
    buffer_load_dwordx4 v2, s[32:35], s60 offen lds
    s_add_u32 s62, s61, 16384
    s_mov_b32 m0, s62
    s_nop 0
    buffer_load_dwordx4 v2, s[44:47], s60 offen lds
    s_add_u32 s60, s60, 1024
    s_add_u32 s61, s61, 1024
    s_mov_b32 m0, s61
    s_nop 0
    buffer_load_dwordx4 v2, s[32:35], s60 offen lds
    s_add_u32 s62, s61, 16384
    s_mov_b32 m0, s62
    s_nop 0
    buffer_load_dwordx4 v2, s[44:47], s60 offen lds
    s_add_u32 s60, s60, 1024
    s_add_u32 s61, s61, 1024
K1_STAGED:
    v_lshrrev_b32 v2, 2, v1
    s_lshl_b32 s60, s20, 6
    s_lshl_b32 s61, s22, 4
    s_add_u32 s60, s60, s61
    v_add_u32 v3, s60, v2
    v_and_b32 v4, 3, v1
    v_lshlrev_b32 v4, 4, v4
    v_lshl_add_u32 v5, v3, 10, v4
    buffer_load_dwordx4 v[64:67], v5, s[24:27], 0 offen offset:0
    buffer_load_dwordx4 v[68:71], v5, s[24:27], 0 offen offset:64
    buffer_load_dwordx4 v[72:75], v5, s[24:27], 0 offen offset:128
    buffer_load_dwordx4 v[76:79], v5, s[24:27], 0 offen offset:192
    buffer_load_dwordx4 v[80:83], v5, s[24:27], 0 offen offset:256
    buffer_load_dwordx4 v[84:87], v5, s[24:27], 0 offen offset:320
    buffer_load_dwordx4 v[88:91], v5, s[24:27], 0 offen offset:384
    buffer_load_dwordx4 v[92:95], v5, s[24:27], 0 offen offset:448
    buffer_load_dwordx4 v[96:99], v5, s[24:27], 0 offen offset:512
    buffer_load_dwordx4 v[100:103], v5, s[24:27], 0 offen offset:576
    buffer_load_dwordx4 v[104:107], v5, s[24:27], 0 offen offset:640
    buffer_load_dwordx4 v[108:111], v5, s[24:27], 0 offen offset:704
    buffer_load_dwordx4 v[112:115], v5, s[24:27], 0 offen offset:768
    buffer_load_dwordx4 v[116:119], v5, s[24:27], 0 offen offset:832
    buffer_load_dwordx4 v[120:123], v5, s[24:27], 0 offen offset:896
    buffer_load_dwordx4 v[124:127], v5, s[24:27], 0 offen offset:960
    s_cmp_lg_u32 s21, 0
    s_cbranch_scc1 K1_NOWR
    buffer_load_dwordx4 v[128:131], v4, s[40:43], 0 offen offset:0
    buffer_load_dwordx4 v[132:135], v4, s[40:43], 0 offen offset:64
    buffer_load_dwordx4 v[136:139], v4, s[40:43], 0 offen offset:128
    buffer_load_dwordx4 v[140:143], v4, s[40:43], 0 offen offset:192
    buffer_load_dwordx4 v[144:147], v4, s[40:43], 0 offen offset:256
    buffer_load_dwordx4 v[148:151], v4, s[40:43], 0 offen offset:320
    buffer_load_dwordx4 v[152:155], v4, s[40:43], 0 offen offset:384
    buffer_load_dwordx4 v[156:159], v4, s[40:43], 0 offen offset:448
    buffer_load_dwordx4 v[160:163], v4, s[40:43], 0 offen offset:512
    buffer_load_dwordx4 v[164:167], v4, s[40:43], 0 offen offset:576
    buffer_load_dwordx4 v[168:171], v4, s[40:43], 0 offen offset:640
    buffer_load_dwordx4 v[172:175], v4, s[40:43], 0 offen offset:704
    buffer_load_dwordx4 v[176:179], v4, s[40:43], 0 offen offset:768
    buffer_load_dwordx4 v[180:183], v4, s[40:43], 0 offen offset:832
    buffer_load_dwordx4 v[184:187], v4, s[40:43], 0 offen offset:896
    buffer_load_dwordx4 v[188:191], v4, s[40:43], 0 offen offset:960
K1_NOWR:
    s_waitcnt vmcnt(0)
    v_mov_b32 v6, 0
    v_mov_b32 v7, 0
    v_mov_b32 v11, 0x3f803f80
    v_dot2_f32_bf16 v6, v64, v11, v6
    v_dot2_f32_bf16 v7, v64, v64, v7
    v_dot2_f32_bf16 v6, v65, v11, v6
    v_dot2_f32_bf16 v7, v65, v65, v7
    v_dot2_f32_bf16 v6, v66, v11, v6
    v_dot2_f32_bf16 v7, v66, v66, v7
    v_dot2_f32_bf16 v6, v67, v11, v6
    v_dot2_f32_bf16 v7, v67, v67, v7
    v_dot2_f32_bf16 v6, v68, v11, v6
    v_dot2_f32_bf16 v7, v68, v68, v7
    v_dot2_f32_bf16 v6, v69, v11, v6
    v_dot2_f32_bf16 v7, v69, v69, v7
    v_dot2_f32_bf16 v6, v70, v11, v6
    v_dot2_f32_bf16 v7, v70, v70, v7
    v_dot2_f32_bf16 v6, v71, v11, v6
    v_dot2_f32_bf16 v7, v71, v71, v7
    v_dot2_f32_bf16 v6, v72, v11, v6
    v_dot2_f32_bf16 v7, v72, v72, v7
    v_dot2_f32_bf16 v6, v73, v11, v6
    v_dot2_f32_bf16 v7, v73, v73, v7
    v_dot2_f32_bf16 v6, v74, v11, v6
    v_dot2_f32_bf16 v7, v74, v74, v7
    v_dot2_f32_bf16 v6, v75, v11, v6
    v_dot2_f32_bf16 v7, v75, v75, v7
    v_dot2_f32_bf16 v6, v76, v11, v6
    v_dot2_f32_bf16 v7, v76, v76, v7
    v_dot2_f32_bf16 v6, v77, v11, v6
    v_dot2_f32_bf16 v7, v77, v77, v7
    v_dot2_f32_bf16 v6, v78, v11, v6
    v_dot2_f32_bf16 v7, v78, v78, v7
    v_dot2_f32_bf16 v6, v79, v11, v6
    v_dot2_f32_bf16 v7, v79, v79, v7
    v_dot2_f32_bf16 v6, v80, v11, v6
    v_dot2_f32_bf16 v7, v80, v80, v7
    v_dot2_f32_bf16 v6, v81, v11, v6
    v_dot2_f32_bf16 v7, v81, v81, v7
    v_dot2_f32_bf16 v6, v82, v11, v6
    v_dot2_f32_bf16 v7, v82, v82, v7
    v_dot2_f32_bf16 v6, v83, v11, v6
    v_dot2_f32_bf16 v7, v83, v83, v7
    v_dot2_f32_bf16 v6, v84, v11, v6
    v_dot2_f32_bf16 v7, v84, v84, v7
    v_dot2_f32_bf16 v6, v85, v11, v6
    v_dot2_f32_bf16 v7, v85, v85, v7
    v_dot2_f32_bf16 v6, v86, v11, v6
    v_dot2_f32_bf16 v7, v86, v86, v7
    v_dot2_f32_bf16 v6, v87, v11, v6
    v_dot2_f32_bf16 v7, v87, v87, v7
    v_dot2_f32_bf16 v6, v88, v11, v6
    v_dot2_f32_bf16 v7, v88, v88, v7
    v_dot2_f32_bf16 v6, v89, v11, v6
    v_dot2_f32_bf16 v7, v89, v89, v7
    v_dot2_f32_bf16 v6, v90, v11, v6
    v_dot2_f32_bf16 v7, v90, v90, v7
    v_dot2_f32_bf16 v6, v91, v11, v6
    v_dot2_f32_bf16 v7, v91, v91, v7
    v_dot2_f32_bf16 v6, v92, v11, v6
    v_dot2_f32_bf16 v7, v92, v92, v7
    v_dot2_f32_bf16 v6, v93, v11, v6
    v_dot2_f32_bf16 v7, v93, v93, v7
    v_dot2_f32_bf16 v6, v94, v11, v6
    v_dot2_f32_bf16 v7, v94, v94, v7
    v_dot2_f32_bf16 v6, v95, v11, v6
    v_dot2_f32_bf16 v7, v95, v95, v7
    v_dot2_f32_bf16 v6, v96, v11, v6
    v_dot2_f32_bf16 v7, v96, v96, v7
    v_dot2_f32_bf16 v6, v97, v11, v6
    v_dot2_f32_bf16 v7, v97, v97, v7
    v_dot2_f32_bf16 v6, v98, v11, v6
    v_dot2_f32_bf16 v7, v98, v98, v7
    v_dot2_f32_bf16 v6, v99, v11, v6
    v_dot2_f32_bf16 v7, v99, v99, v7
    v_dot2_f32_bf16 v6, v100, v11, v6
    v_dot2_f32_bf16 v7, v100, v100, v7
    v_dot2_f32_bf16 v6, v101, v11, v6
    v_dot2_f32_bf16 v7, v101, v101, v7
    v_dot2_f32_bf16 v6, v102, v11, v6
    v_dot2_f32_bf16 v7, v102, v102, v7
    v_dot2_f32_bf16 v6, v103, v11, v6
    v_dot2_f32_bf16 v7, v103, v103, v7
    v_dot2_f32_bf16 v6, v104, v11, v6
    v_dot2_f32_bf16 v7, v104, v104, v7
    v_dot2_f32_bf16 v6, v105, v11, v6
    v_dot2_f32_bf16 v7, v105, v105, v7
    v_dot2_f32_bf16 v6, v106, v11, v6
    v_dot2_f32_bf16 v7, v106, v106, v7
    v_dot2_f32_bf16 v6, v107, v11, v6
    v_dot2_f32_bf16 v7, v107, v107, v7
    v_dot2_f32_bf16 v6, v108, v11, v6
    v_dot2_f32_bf16 v7, v108, v108, v7
    v_dot2_f32_bf16 v6, v109, v11, v6
    v_dot2_f32_bf16 v7, v109, v109, v7
    v_dot2_f32_bf16 v6, v110, v11, v6
    v_dot2_f32_bf16 v7, v110, v110, v7
    v_dot2_f32_bf16 v6, v111, v11, v6
    v_dot2_f32_bf16 v7, v111, v111, v7
    v_dot2_f32_bf16 v6, v112, v11, v6
    v_dot2_f32_bf16 v7, v112, v112, v7
    v_dot2_f32_bf16 v6, v113, v11, v6
    v_dot2_f32_bf16 v7, v113, v113, v7
    v_dot2_f32_bf16 v6, v114, v11, v6
    v_dot2_f32_bf16 v7, v114, v114, v7
    v_dot2_f32_bf16 v6, v115, v11, v6
    v_dot2_f32_bf16 v7, v115, v115, v7
    v_dot2_f32_bf16 v6, v116, v11, v6
    v_dot2_f32_bf16 v7, v116, v116, v7
    v_dot2_f32_bf16 v6, v117, v11, v6
    v_dot2_f32_bf16 v7, v117, v117, v7
    v_dot2_f32_bf16 v6, v118, v11, v6
    v_dot2_f32_bf16 v7, v118, v118, v7
    v_dot2_f32_bf16 v6, v119, v11, v6
    v_dot2_f32_bf16 v7, v119, v119, v7
    v_dot2_f32_bf16 v6, v120, v11, v6
    v_dot2_f32_bf16 v7, v120, v120, v7
    v_dot2_f32_bf16 v6, v121, v11, v6
    v_dot2_f32_bf16 v7, v121, v121, v7
    v_dot2_f32_bf16 v6, v122, v11, v6
    v_dot2_f32_bf16 v7, v122, v122, v7
    v_dot2_f32_bf16 v6, v123, v11, v6
    v_dot2_f32_bf16 v7, v123, v123, v7
    v_dot2_f32_bf16 v6, v124, v11, v6
    v_dot2_f32_bf16 v7, v124, v124, v7
    v_dot2_f32_bf16 v6, v125, v11, v6
    v_dot2_f32_bf16 v7, v125, v125, v7
    v_dot2_f32_bf16 v6, v126, v11, v6
    v_dot2_f32_bf16 v7, v126, v126, v7
    v_dot2_f32_bf16 v6, v127, v11, v6
    v_dot2_f32_bf16 v7, v127, v127, v7
    s_nop 4
    s_nop 1
    v_add_f32_dpp v6, v6, v6 quad_perm:[1,0,3,2] row_mask:0xf bank_mask:0xf
    s_nop 1
    v_add_f32_dpp v6, v6, v6 quad_perm:[2,3,0,1] row_mask:0xf bank_mask:0xf
    s_nop 1
    v_add_f32_dpp v7, v7, v7 quad_perm:[1,0,3,2] row_mask:0xf bank_mask:0xf
    s_nop 1
    v_add_f32_dpp v7, v7, v7 quad_perm:[2,3,0,1] row_mask:0xf bank_mask:0xf
    v_mul_f32 v6, 0x3b000000, v6
    v_mul_f32 v7, 0x3b000000, v7
    v_fma_f32 v7, -v6, v6, v7
    v_max_f32 v7, 0, v7
    v_cvt_pk_bf16_f32 v8, v6, v7
    v_lshlrev_b32 v6, 16, v8
    v_and_b32 v7, 0xffff0000, v8
    v_add_f32 v7, 0x3727c5ac, v7
    v_cvt_pk_bf16_f32 v7, v7, v7
    v_lshlrev_b32 v7, 16, v7
    v_sqrt_f32 v7, v7
    s_nop 0
    v_cvt_pk_bf16_f32 v7, v7, v7
    v_lshlrev_b32 v7, 16, v7
    v_rcp_f32 v7, v7
    s_nop 0
    v_mul_f32 v6, v6, v7
    v_sub_f32 v6, 0, v6
    v_lshlrev_b32 v8, 16, v64
    v_and_b32 v9, 0xffff0000, v64
    v_fma_f32 v8, v8, v7, v6
    v_fma_f32 v9, v9, v7, v6
    v_cvt_pk_bf16_f32 v64, v8, v9
    v_lshlrev_b32 v8, 16, v65
    v_and_b32 v9, 0xffff0000, v65
    v_fma_f32 v8, v8, v7, v6
    v_fma_f32 v9, v9, v7, v6
    v_cvt_pk_bf16_f32 v65, v8, v9
    v_lshlrev_b32 v8, 16, v66
    v_and_b32 v9, 0xffff0000, v66
    v_fma_f32 v8, v8, v7, v6
    v_fma_f32 v9, v9, v7, v6
    v_cvt_pk_bf16_f32 v66, v8, v9
    v_lshlrev_b32 v8, 16, v67
    v_and_b32 v9, 0xffff0000, v67
    v_fma_f32 v8, v8, v7, v6
    v_fma_f32 v9, v9, v7, v6
    v_cvt_pk_bf16_f32 v67, v8, v9
    v_lshlrev_b32 v8, 16, v68
    v_and_b32 v9, 0xffff0000, v68
    v_fma_f32 v8, v8, v7, v6
    v_fma_f32 v9, v9, v7, v6
    v_cvt_pk_bf16_f32 v68, v8, v9
    v_lshlrev_b32 v8, 16, v69
    v_and_b32 v9, 0xffff0000, v69
    v_fma_f32 v8, v8, v7, v6
    v_fma_f32 v9, v9, v7, v6
    v_cvt_pk_bf16_f32 v69, v8, v9
    v_lshlrev_b32 v8, 16, v70
    v_and_b32 v9, 0xffff0000, v70
    v_fma_f32 v8, v8, v7, v6
    v_fma_f32 v9, v9, v7, v6
    v_cvt_pk_bf16_f32 v70, v8, v9
    v_lshlrev_b32 v8, 16, v71
    v_and_b32 v9, 0xffff0000, v71
    v_fma_f32 v8, v8, v7, v6
    v_fma_f32 v9, v9, v7, v6
    v_cvt_pk_bf16_f32 v71, v8, v9
    v_lshlrev_b32 v8, 16, v72
    v_and_b32 v9, 0xffff0000, v72
    v_fma_f32 v8, v8, v7, v6
    v_fma_f32 v9, v9, v7, v6
    v_cvt_pk_bf16_f32 v72, v8, v9
    v_lshlrev_b32 v8, 16, v73
    v_and_b32 v9, 0xffff0000, v73
    v_fma_f32 v8, v8, v7, v6
    v_fma_f32 v9, v9, v7, v6
    v_cvt_pk_bf16_f32 v73, v8, v9
    v_lshlrev_b32 v8, 16, v74
    v_and_b32 v9, 0xffff0000, v74
    v_fma_f32 v8, v8, v7, v6
    v_fma_f32 v9, v9, v7, v6
    v_cvt_pk_bf16_f32 v74, v8, v9
    v_lshlrev_b32 v8, 16, v75
    v_and_b32 v9, 0xffff0000, v75
    v_fma_f32 v8, v8, v7, v6
    v_fma_f32 v9, v9, v7, v6
    v_cvt_pk_bf16_f32 v75, v8, v9
    v_lshlrev_b32 v8, 16, v76
    v_and_b32 v9, 0xffff0000, v76
    v_fma_f32 v8, v8, v7, v6
    v_fma_f32 v9, v9, v7, v6
    v_cvt_pk_bf16_f32 v76, v8, v9
    v_lshlrev_b32 v8, 16, v77
    v_and_b32 v9, 0xffff0000, v77
    v_fma_f32 v8, v8, v7, v6
    v_fma_f32 v9, v9, v7, v6
    v_cvt_pk_bf16_f32 v77, v8, v9
    v_lshlrev_b32 v8, 16, v78
    v_and_b32 v9, 0xffff0000, v78
    v_fma_f32 v8, v8, v7, v6
    v_fma_f32 v9, v9, v7, v6
    v_cvt_pk_bf16_f32 v78, v8, v9
    v_lshlrev_b32 v8, 16, v79
    v_and_b32 v9, 0xffff0000, v79
    v_fma_f32 v8, v8, v7, v6
    v_fma_f32 v9, v9, v7, v6
    v_cvt_pk_bf16_f32 v79, v8, v9
    v_lshlrev_b32 v8, 16, v80
    v_and_b32 v9, 0xffff0000, v80
    v_fma_f32 v8, v8, v7, v6
    v_fma_f32 v9, v9, v7, v6
    v_cvt_pk_bf16_f32 v80, v8, v9
    v_lshlrev_b32 v8, 16, v81
    v_and_b32 v9, 0xffff0000, v81
    v_fma_f32 v8, v8, v7, v6
    v_fma_f32 v9, v9, v7, v6
    v_cvt_pk_bf16_f32 v81, v8, v9
    v_lshlrev_b32 v8, 16, v82
    v_and_b32 v9, 0xffff0000, v82
    v_fma_f32 v8, v8, v7, v6
    v_fma_f32 v9, v9, v7, v6
    v_cvt_pk_bf16_f32 v82, v8, v9
    v_lshlrev_b32 v8, 16, v83
    v_and_b32 v9, 0xffff0000, v83
    v_fma_f32 v8, v8, v7, v6
    v_fma_f32 v9, v9, v7, v6
    v_cvt_pk_bf16_f32 v83, v8, v9
    v_lshlrev_b32 v8, 16, v84
    v_and_b32 v9, 0xffff0000, v84
    v_fma_f32 v8, v8, v7, v6
    v_fma_f32 v9, v9, v7, v6
    v_cvt_pk_bf16_f32 v84, v8, v9
    v_lshlrev_b32 v8, 16, v85
    v_and_b32 v9, 0xffff0000, v85
    v_fma_f32 v8, v8, v7, v6
    v_fma_f32 v9, v9, v7, v6
    v_cvt_pk_bf16_f32 v85, v8, v9
    v_lshlrev_b32 v8, 16, v86
    v_and_b32 v9, 0xffff0000, v86
    v_fma_f32 v8, v8, v7, v6
    v_fma_f32 v9, v9, v7, v6
    v_cvt_pk_bf16_f32 v86, v8, v9
    v_lshlrev_b32 v8, 16, v87
    v_and_b32 v9, 0xffff0000, v87
    v_fma_f32 v8, v8, v7, v6
    v_fma_f32 v9, v9, v7, v6
    v_cvt_pk_bf16_f32 v87, v8, v9
    v_lshlrev_b32 v8, 16, v88
    v_and_b32 v9, 0xffff0000, v88
    v_fma_f32 v8, v8, v7, v6
    v_fma_f32 v9, v9, v7, v6
    v_cvt_pk_bf16_f32 v88, v8, v9
    v_lshlrev_b32 v8, 16, v89
    v_and_b32 v9, 0xffff0000, v89
    v_fma_f32 v8, v8, v7, v6
    v_fma_f32 v9, v9, v7, v6
    v_cvt_pk_bf16_f32 v89, v8, v9
    v_lshlrev_b32 v8, 16, v90
    v_and_b32 v9, 0xffff0000, v90
    v_fma_f32 v8, v8, v7, v6
    v_fma_f32 v9, v9, v7, v6
    v_cvt_pk_bf16_f32 v90, v8, v9
    v_lshlrev_b32 v8, 16, v91
    v_and_b32 v9, 0xffff0000, v91
    v_fma_f32 v8, v8, v7, v6
    v_fma_f32 v9, v9, v7, v6
    v_cvt_pk_bf16_f32 v91, v8, v9
    v_lshlrev_b32 v8, 16, v92
    v_and_b32 v9, 0xffff0000, v92
    v_fma_f32 v8, v8, v7, v6
    v_fma_f32 v9, v9, v7, v6
    v_cvt_pk_bf16_f32 v92, v8, v9
    v_lshlrev_b32 v8, 16, v93
    v_and_b32 v9, 0xffff0000, v93
    v_fma_f32 v8, v8, v7, v6
    v_fma_f32 v9, v9, v7, v6
    v_cvt_pk_bf16_f32 v93, v8, v9
    v_lshlrev_b32 v8, 16, v94
    v_and_b32 v9, 0xffff0000, v94
    v_fma_f32 v8, v8, v7, v6
    v_fma_f32 v9, v9, v7, v6
    v_cvt_pk_bf16_f32 v94, v8, v9
    v_lshlrev_b32 v8, 16, v95
    v_and_b32 v9, 0xffff0000, v95
    v_fma_f32 v8, v8, v7, v6
    v_fma_f32 v9, v9, v7, v6
    v_cvt_pk_bf16_f32 v95, v8, v9
    v_lshlrev_b32 v8, 16, v96
    v_and_b32 v9, 0xffff0000, v96
    v_fma_f32 v8, v8, v7, v6
    v_fma_f32 v9, v9, v7, v6
    v_cvt_pk_bf16_f32 v96, v8, v9
    v_lshlrev_b32 v8, 16, v97
    v_and_b32 v9, 0xffff0000, v97
    v_fma_f32 v8, v8, v7, v6
    v_fma_f32 v9, v9, v7, v6
    v_cvt_pk_bf16_f32 v97, v8, v9
    v_lshlrev_b32 v8, 16, v98
    v_and_b32 v9, 0xffff0000, v98
    v_fma_f32 v8, v8, v7, v6
    v_fma_f32 v9, v9, v7, v6
    v_cvt_pk_bf16_f32 v98, v8, v9
    v_lshlrev_b32 v8, 16, v99
    v_and_b32 v9, 0xffff0000, v99
    v_fma_f32 v8, v8, v7, v6
    v_fma_f32 v9, v9, v7, v6
    v_cvt_pk_bf16_f32 v99, v8, v9
    v_lshlrev_b32 v8, 16, v100
    v_and_b32 v9, 0xffff0000, v100
    v_fma_f32 v8, v8, v7, v6
    v_fma_f32 v9, v9, v7, v6
    v_cvt_pk_bf16_f32 v100, v8, v9
    v_lshlrev_b32 v8, 16, v101
    v_and_b32 v9, 0xffff0000, v101
    v_fma_f32 v8, v8, v7, v6
    v_fma_f32 v9, v9, v7, v6
    v_cvt_pk_bf16_f32 v101, v8, v9
    v_lshlrev_b32 v8, 16, v102
    v_and_b32 v9, 0xffff0000, v102
    v_fma_f32 v8, v8, v7, v6
    v_fma_f32 v9, v9, v7, v6
    v_cvt_pk_bf16_f32 v102, v8, v9
    v_lshlrev_b32 v8, 16, v103
    v_and_b32 v9, 0xffff0000, v103
    v_fma_f32 v8, v8, v7, v6
    v_fma_f32 v9, v9, v7, v6
    v_cvt_pk_bf16_f32 v103, v8, v9
    v_lshlrev_b32 v8, 16, v104
    v_and_b32 v9, 0xffff0000, v104
    v_fma_f32 v8, v8, v7, v6
    v_fma_f32 v9, v9, v7, v6
    v_cvt_pk_bf16_f32 v104, v8, v9
    v_lshlrev_b32 v8, 16, v105
    v_and_b32 v9, 0xffff0000, v105
    v_fma_f32 v8, v8, v7, v6
    v_fma_f32 v9, v9, v7, v6
    v_cvt_pk_bf16_f32 v105, v8, v9
    v_lshlrev_b32 v8, 16, v106
    v_and_b32 v9, 0xffff0000, v106
    v_fma_f32 v8, v8, v7, v6
    v_fma_f32 v9, v9, v7, v6
    v_cvt_pk_bf16_f32 v106, v8, v9
    v_lshlrev_b32 v8, 16, v107
    v_and_b32 v9, 0xffff0000, v107
    v_fma_f32 v8, v8, v7, v6
    v_fma_f32 v9, v9, v7, v6
    v_cvt_pk_bf16_f32 v107, v8, v9
    v_lshlrev_b32 v8, 16, v108
    v_and_b32 v9, 0xffff0000, v108
    v_fma_f32 v8, v8, v7, v6
    v_fma_f32 v9, v9, v7, v6
    v_cvt_pk_bf16_f32 v108, v8, v9
    v_lshlrev_b32 v8, 16, v109
    v_and_b32 v9, 0xffff0000, v109
    v_fma_f32 v8, v8, v7, v6
    v_fma_f32 v9, v9, v7, v6
    v_cvt_pk_bf16_f32 v109, v8, v9
    v_lshlrev_b32 v8, 16, v110
    v_and_b32 v9, 0xffff0000, v110
    v_fma_f32 v8, v8, v7, v6
    v_fma_f32 v9, v9, v7, v6
    v_cvt_pk_bf16_f32 v110, v8, v9
    v_lshlrev_b32 v8, 16, v111
    v_and_b32 v9, 0xffff0000, v111
    v_fma_f32 v8, v8, v7, v6
    v_fma_f32 v9, v9, v7, v6
    v_cvt_pk_bf16_f32 v111, v8, v9
    v_lshlrev_b32 v8, 16, v112
    v_and_b32 v9, 0xffff0000, v112
    v_fma_f32 v8, v8, v7, v6
    v_fma_f32 v9, v9, v7, v6
    v_cvt_pk_bf16_f32 v112, v8, v9
    v_lshlrev_b32 v8, 16, v113
    v_and_b32 v9, 0xffff0000, v113
    v_fma_f32 v8, v8, v7, v6
    v_fma_f32 v9, v9, v7, v6
    v_cvt_pk_bf16_f32 v113, v8, v9
    v_lshlrev_b32 v8, 16, v114
    v_and_b32 v9, 0xffff0000, v114
    v_fma_f32 v8, v8, v7, v6
    v_fma_f32 v9, v9, v7, v6
    v_cvt_pk_bf16_f32 v114, v8, v9
    v_lshlrev_b32 v8, 16, v115
    v_and_b32 v9, 0xffff0000, v115
    v_fma_f32 v8, v8, v7, v6
    v_fma_f32 v9, v9, v7, v6
    v_cvt_pk_bf16_f32 v115, v8, v9
    v_lshlrev_b32 v8, 16, v116
    v_and_b32 v9, 0xffff0000, v116
    v_fma_f32 v8, v8, v7, v6
    v_fma_f32 v9, v9, v7, v6
    v_cvt_pk_bf16_f32 v116, v8, v9
    v_lshlrev_b32 v8, 16, v117
    v_and_b32 v9, 0xffff0000, v117
    v_fma_f32 v8, v8, v7, v6
    v_fma_f32 v9, v9, v7, v6
    v_cvt_pk_bf16_f32 v117, v8, v9
    v_lshlrev_b32 v8, 16, v118
    v_and_b32 v9, 0xffff0000, v118
    v_fma_f32 v8, v8, v7, v6
    v_fma_f32 v9, v9, v7, v6
    v_cvt_pk_bf16_f32 v118, v8, v9
    v_lshlrev_b32 v8, 16, v119
    v_and_b32 v9, 0xffff0000, v119
    v_fma_f32 v8, v8, v7, v6
    v_fma_f32 v9, v9, v7, v6
    v_cvt_pk_bf16_f32 v119, v8, v9
    v_lshlrev_b32 v8, 16, v120
    v_and_b32 v9, 0xffff0000, v120
    v_fma_f32 v8, v8, v7, v6
    v_fma_f32 v9, v9, v7, v6
    v_cvt_pk_bf16_f32 v120, v8, v9
    v_lshlrev_b32 v8, 16, v121
    v_and_b32 v9, 0xffff0000, v121
    v_fma_f32 v8, v8, v7, v6
    v_fma_f32 v9, v9, v7, v6
    v_cvt_pk_bf16_f32 v121, v8, v9
    v_lshlrev_b32 v8, 16, v122
    v_and_b32 v9, 0xffff0000, v122
    v_fma_f32 v8, v8, v7, v6
    v_fma_f32 v9, v9, v7, v6
    v_cvt_pk_bf16_f32 v122, v8, v9
    v_lshlrev_b32 v8, 16, v123
    v_and_b32 v9, 0xffff0000, v123
    v_fma_f32 v8, v8, v7, v6
    v_fma_f32 v9, v9, v7, v6
    v_cvt_pk_bf16_f32 v123, v8, v9
    v_lshlrev_b32 v8, 16, v124
    v_and_b32 v9, 0xffff0000, v124
    v_fma_f32 v8, v8, v7, v6
    v_fma_f32 v9, v9, v7, v6
    v_cvt_pk_bf16_f32 v124, v8, v9
    v_lshlrev_b32 v8, 16, v125
    v_and_b32 v9, 0xffff0000, v125
    v_fma_f32 v8, v8, v7, v6
    v_fma_f32 v9, v9, v7, v6
    v_cvt_pk_bf16_f32 v125, v8, v9
    v_lshlrev_b32 v8, 16, v126
    v_and_b32 v9, 0xffff0000, v126
    v_fma_f32 v8, v8, v7, v6
    v_fma_f32 v9, v9, v7, v6
    v_cvt_pk_bf16_f32 v126, v8, v9
    v_lshlrev_b32 v8, 16, v127
    v_and_b32 v9, 0xffff0000, v127
    v_fma_f32 v8, v8, v7, v6
    v_fma_f32 v9, v9, v7, v6
    v_cvt_pk_bf16_f32 v127, v8, v9
    v_sub_u32 v8, v3, s60
    s_lshl_b32 s62, s22, 4
    v_add_u32 v8, s62, v8
    v_mul_u32_u24 v8, 1040, v8
    v_add_u32 v8, v8, v4
    ds_write_b128 v8, v[64:67] offset:0
    ds_write_b128 v8, v[68:71] offset:64
    ds_write_b128 v8, v[72:75] offset:128
    ds_write_b128 v8, v[76:79] offset:192
    ds_write_b128 v8, v[80:83] offset:256
    ds_write_b128 v8, v[84:87] offset:320
    ds_write_b128 v8, v[88:91] offset:384
    ds_write_b128 v8, v[92:95] offset:448
    ds_write_b128 v8, v[96:99] offset:512
    ds_write_b128 v8, v[100:103] offset:576
    ds_write_b128 v8, v[104:107] offset:640
    ds_write_b128 v8, v[108:111] offset:704
    ds_write_b128 v8, v[112:115] offset:768
    ds_write_b128 v8, v[116:119] offset:832
    ds_write_b128 v8, v[120:123] offset:896
    ds_write_b128 v8, v[124:127] offset:960
    s_cmp_lg_u32 s21, 0
    s_cbranch_scc1 K1_NOXN
    buffer_store_dwordx4 v[64:67], v5, s[36:39], 0 offen offset:0
    buffer_store_dwordx4 v[68:71], v5, s[36:39], 0 offen offset:64
    buffer_store_dwordx4 v[72:75], v5, s[36:39], 0 offen offset:128
    buffer_store_dwordx4 v[76:79], v5, s[36:39], 0 offen offset:192
    buffer_store_dwordx4 v[80:83], v5, s[36:39], 0 offen offset:256
    buffer_store_dwordx4 v[84:87], v5, s[36:39], 0 offen offset:320
    buffer_store_dwordx4 v[88:91], v5, s[36:39], 0 offen offset:384
    buffer_store_dwordx4 v[92:95], v5, s[36:39], 0 offen offset:448
    buffer_store_dwordx4 v[96:99], v5, s[36:39], 0 offen offset:512
    buffer_store_dwordx4 v[100:103], v5, s[36:39], 0 offen offset:576
    buffer_store_dwordx4 v[104:107], v5, s[36:39], 0 offen offset:640
    buffer_store_dwordx4 v[108:111], v5, s[36:39], 0 offen offset:704
    buffer_store_dwordx4 v[112:115], v5, s[36:39], 0 offen offset:768
    buffer_store_dwordx4 v[116:119], v5, s[36:39], 0 offen offset:832
    buffer_store_dwordx4 v[120:123], v5, s[36:39], 0 offen offset:896
    buffer_store_dwordx4 v[124:127], v5, s[36:39], 0 offen offset:960
    v_mov_b32 v9, 0
    v_dot2_f32_bf16 v9, v64, v128, v9
    v_dot2_f32_bf16 v9, v65, v129, v9
    v_dot2_f32_bf16 v9, v66, v130, v9
    v_dot2_f32_bf16 v9, v67, v131, v9
    v_dot2_f32_bf16 v9, v68, v132, v9
    v_dot2_f32_bf16 v9, v69, v133, v9
    v_dot2_f32_bf16 v9, v70, v134, v9
    v_dot2_f32_bf16 v9, v71, v135, v9
    v_dot2_f32_bf16 v9, v72, v136, v9
    v_dot2_f32_bf16 v9, v73, v137, v9
    v_dot2_f32_bf16 v9, v74, v138, v9
    v_dot2_f32_bf16 v9, v75, v139, v9
    v_dot2_f32_bf16 v9, v76, v140, v9
    v_dot2_f32_bf16 v9, v77, v141, v9
    v_dot2_f32_bf16 v9, v78, v142, v9
    v_dot2_f32_bf16 v9, v79, v143, v9
    v_dot2_f32_bf16 v9, v80, v144, v9
    v_dot2_f32_bf16 v9, v81, v145, v9
    v_dot2_f32_bf16 v9, v82, v146, v9
    v_dot2_f32_bf16 v9, v83, v147, v9
    v_dot2_f32_bf16 v9, v84, v148, v9
    v_dot2_f32_bf16 v9, v85, v149, v9
    v_dot2_f32_bf16 v9, v86, v150, v9
    v_dot2_f32_bf16 v9, v87, v151, v9
    v_dot2_f32_bf16 v9, v88, v152, v9
    v_dot2_f32_bf16 v9, v89, v153, v9
    v_dot2_f32_bf16 v9, v90, v154, v9
    v_dot2_f32_bf16 v9, v91, v155, v9
    v_dot2_f32_bf16 v9, v92, v156, v9
    v_dot2_f32_bf16 v9, v93, v157, v9
    v_dot2_f32_bf16 v9, v94, v158, v9
    v_dot2_f32_bf16 v9, v95, v159, v9
    v_dot2_f32_bf16 v9, v96, v160, v9
    v_dot2_f32_bf16 v9, v97, v161, v9
    v_dot2_f32_bf16 v9, v98, v162, v9
    v_dot2_f32_bf16 v9, v99, v163, v9
    v_dot2_f32_bf16 v9, v100, v164, v9
    v_dot2_f32_bf16 v9, v101, v165, v9
    v_dot2_f32_bf16 v9, v102, v166, v9
    v_dot2_f32_bf16 v9, v103, v167, v9
    v_dot2_f32_bf16 v9, v104, v168, v9
    v_dot2_f32_bf16 v9, v105, v169, v9
    v_dot2_f32_bf16 v9, v106, v170, v9
    v_dot2_f32_bf16 v9, v107, v171, v9
    v_dot2_f32_bf16 v9, v108, v172, v9
    v_dot2_f32_bf16 v9, v109, v173, v9
    v_dot2_f32_bf16 v9, v110, v174, v9
    v_dot2_f32_bf16 v9, v111, v175, v9
    v_dot2_f32_bf16 v9, v112, v176, v9
    v_dot2_f32_bf16 v9, v113, v177, v9
    v_dot2_f32_bf16 v9, v114, v178, v9
    v_dot2_f32_bf16 v9, v115, v179, v9
    v_dot2_f32_bf16 v9, v116, v180, v9
    v_dot2_f32_bf16 v9, v117, v181, v9
    v_dot2_f32_bf16 v9, v118, v182, v9
    v_dot2_f32_bf16 v9, v119, v183, v9
    v_dot2_f32_bf16 v9, v120, v184, v9
    v_dot2_f32_bf16 v9, v121, v185, v9
    v_dot2_f32_bf16 v9, v122, v186, v9
    v_dot2_f32_bf16 v9, v123, v187, v9
    v_dot2_f32_bf16 v9, v124, v188, v9
    v_dot2_f32_bf16 v9, v125, v189, v9
    v_dot2_f32_bf16 v9, v126, v190, v9
    v_dot2_f32_bf16 v9, v127, v191, v9
    s_nop 4
    s_nop 1
    v_add_f32_dpp v9, v9, v9 quad_perm:[1,0,3,2] row_mask:0xf bank_mask:0xf
    s_nop 1
    v_add_f32_dpp v9, v9, v9 quad_perm:[2,3,0,1] row_mask:0xf bank_mask:0xf
    v_cvt_pk_bf16_f32 v9, v9, v9
    v_lshlrev_b32 v9, 16, v9
    v_lshlrev_b32 v10, 2, v3
    v_add_u32 v10, 4325376, v10
    v_and_b32 v11, 3, v1
    v_cmp_eq_u32 vcc, 0, v11
    s_and_saveexec_b64 s[62:63], vcc
    buffer_store_dword v9, v10, s[36:39], 0 offen
    s_mov_b64 exec, s[62:63]
K1_NOXN:
    s_waitcnt vmcnt(0) lgkmcnt(0)
    s_barrier
    v_and_b32 v8, 31, v1
    s_lshl_b32 s62, s23, 5
    v_add_u32 v8, s62, v8
    v_mul_u32_u24 v9, 1040, v8
    v_lshrrev_b32 v10, 5, v1
    v_lshl_add_u32 v9, v10, 4, v9
    s_lshl_b32 s63, s20, 6
    v_add_u32 v8, s63, v8
    s_cmp_eq_u32 s21, 8
    s_cbranch_scc1 K1_KV
    s_lshl_b32 s62, s19, 6
    v_lshrrev_b32 v12, 5, v1
    v_lshlrev_b32 v11, 10, v12
    v_bfe_u32 v12, v1, 2, 2
    v_lshl_add_u32 v11, v12, 7, v11
    v_bfe_u32 v12, v1, 4, 1
    v_lshl_add_u32 v11, v12, 5, v11
    v_and_b32 v12, 3, v1
    v_lshl_add_u32 v11, v12, 3, v11
    v_add_u32 v11, s62, v11
    v_add_u32 v11, 66560, v11
    v_mov_b32 v16, 0
    v_mov_b32 v17, 0
    v_mov_b32 v18, 0
    v_mov_b32 v19, 0
    v_mov_b32 v20, 0
    v_mov_b32 v21, 0
    v_mov_b32 v22, 0
    v_mov_b32 v23, 0
    v_mov_b32 v24, 0
    v_mov_b32 v25, 0
    v_mov_b32 v26, 0
    v_mov_b32 v27, 0
    v_mov_b32 v28, 0
    v_mov_b32 v29, 0
    v_mov_b32 v30, 0
    v_mov_b32 v31, 0
    ds_read_b64_tr_b16 v[32:33], v11 offset:0
    ds_read_b64_tr_b16 v[34:35], v11 offset:512
    ds_read_b128 v[48:51], v9 offset:0
    ds_read_b64_tr_b16 v[36:37], v11 offset:2048
    ds_read_b64_tr_b16 v[38:39], v11 offset:2560
    ds_read_b128 v[52:55], v9 offset:32
    ds_read_b64_tr_b16 v[40:41], v11 offset:4096
    ds_read_b64_tr_b16 v[42:43], v11 offset:4608
    ds_read_b128 v[56:59], v9 offset:64
    ds_read_b64_tr_b16 v[44:45], v11 offset:6144
    ds_read_b64_tr_b16 v[46:47], v11 offset:6656
    ds_read_b128 v[60:63], v9 offset:96
    s_waitcnt lgkmcnt(0)
    v_mfma_f32_32x32x16_bf16 v[16:31], v[32:35], v[48:51], v[16:31]
    v_mfma_f32_32x32x16_bf16 v[16:31], v[36:39], v[52:55], v[16:31]
    v_mfma_f32_32x32x16_bf16 v[16:31], v[40:43], v[56:59], v[16:31]
    v_mfma_f32_32x32x16_bf16 v[16:31], v[44:47], v[60:63], v[16:31]
    ds_read_b64_tr_b16 v[32:33], v11 offset:8192
    ds_read_b64_tr_b16 v[34:35], v11 offset:8704
    ds_read_b128 v[48:51], v9 offset:128
    ds_read_b64_tr_b16 v[36:37], v11 offset:10240
    ds_read_b64_tr_b16 v[38:39], v11 offset:10752
    ds_read_b128 v[52:55], v9 offset:160
    ds_read_b64_tr_b16 v[40:41], v11 offset:12288
    ds_read_b64_tr_b16 v[42:43], v11 offset:12800
    ds_read_b128 v[56:59], v9 offset:192
    ds_read_b64_tr_b16 v[44:45], v11 offset:14336
    ds_read_b64_tr_b16 v[46:47], v11 offset:14848
    ds_read_b128 v[60:63], v9 offset:224
    s_waitcnt lgkmcnt(0)
    v_mfma_f32_32x32x16_bf16 v[16:31], v[32:35], v[48:51], v[16:31]
    v_mfma_f32_32x32x16_bf16 v[16:31], v[36:39], v[52:55], v[16:31]
    v_mfma_f32_32x32x16_bf16 v[16:31], v[40:43], v[56:59], v[16:31]
    v_mfma_f32_32x32x16_bf16 v[16:31], v[44:47], v[60:63], v[16:31]
    ds_read_b64_tr_b16 v[32:33], v11 offset:16384
    ds_read_b64_tr_b16 v[34:35], v11 offset:16896
    ds_read_b128 v[48:51], v9 offset:256
    ds_read_b64_tr_b16 v[36:37], v11 offset:18432
    ds_read_b64_tr_b16 v[38:39], v11 offset:18944
    ds_read_b128 v[52:55], v9 offset:288
    ds_read_b64_tr_b16 v[40:41], v11 offset:20480
    ds_read_b64_tr_b16 v[42:43], v11 offset:20992
    ds_read_b128 v[56:59], v9 offset:320
    ds_read_b64_tr_b16 v[44:45], v11 offset:22528
    ds_read_b64_tr_b16 v[46:47], v11 offset:23040
    ds_read_b128 v[60:63], v9 offset:352
    s_waitcnt lgkmcnt(0)
    v_mfma_f32_32x32x16_bf16 v[16:31], v[32:35], v[48:51], v[16:31]
    v_mfma_f32_32x32x16_bf16 v[16:31], v[36:39], v[52:55], v[16:31]
    v_mfma_f32_32x32x16_bf16 v[16:31], v[40:43], v[56:59], v[16:31]
    v_mfma_f32_32x32x16_bf16 v[16:31], v[44:47], v[60:63], v[16:31]
    ds_read_b64_tr_b16 v[32:33], v11 offset:24576
    ds_read_b64_tr_b16 v[34:35], v11 offset:25088
    ds_read_b128 v[48:51], v9 offset:384
    ds_read_b64_tr_b16 v[36:37], v11 offset:26624
    ds_read_b64_tr_b16 v[38:39], v11 offset:27136
    ds_read_b128 v[52:55], v9 offset:416
    ds_read_b64_tr_b16 v[40:41], v11 offset:28672
    ds_read_b64_tr_b16 v[42:43], v11 offset:29184
    ds_read_b128 v[56:59], v9 offset:448
    ds_read_b64_tr_b16 v[44:45], v11 offset:30720
    ds_read_b64_tr_b16 v[46:47], v11 offset:31232
    ds_read_b128 v[60:63], v9 offset:480
    s_waitcnt lgkmcnt(0)
    v_mfma_f32_32x32x16_bf16 v[16:31], v[32:35], v[48:51], v[16:31]
    v_mfma_f32_32x32x16_bf16 v[16:31], v[36:39], v[52:55], v[16:31]
    v_mfma_f32_32x32x16_bf16 v[16:31], v[40:43], v[56:59], v[16:31]
    v_mfma_f32_32x32x16_bf16 v[16:31], v[44:47], v[60:63], v[16:31]
    ds_read_b64_tr_b16 v[32:33], v11 offset:32768
    ds_read_b64_tr_b16 v[34:35], v11 offset:33280
    ds_read_b128 v[48:51], v9 offset:512
    ds_read_b64_tr_b16 v[36:37], v11 offset:34816
    ds_read_b64_tr_b16 v[38:39], v11 offset:35328
    ds_read_b128 v[52:55], v9 offset:544
    ds_read_b64_tr_b16 v[40:41], v11 offset:36864
    ds_read_b64_tr_b16 v[42:43], v11 offset:37376
    ds_read_b128 v[56:59], v9 offset:576
    ds_read_b64_tr_b16 v[44:45], v11 offset:38912
    ds_read_b64_tr_b16 v[46:47], v11 offset:39424
    ds_read_b128 v[60:63], v9 offset:608
    s_waitcnt lgkmcnt(0)
    v_mfma_f32_32x32x16_bf16 v[16:31], v[32:35], v[48:51], v[16:31]
    v_mfma_f32_32x32x16_bf16 v[16:31], v[36:39], v[52:55], v[16:31]
    v_mfma_f32_32x32x16_bf16 v[16:31], v[40:43], v[56:59], v[16:31]
    v_mfma_f32_32x32x16_bf16 v[16:31], v[44:47], v[60:63], v[16:31]
    ds_read_b64_tr_b16 v[32:33], v11 offset:40960
    ds_read_b64_tr_b16 v[34:35], v11 offset:41472
    ds_read_b128 v[48:51], v9 offset:640
    ds_read_b64_tr_b16 v[36:37], v11 offset:43008
    ds_read_b64_tr_b16 v[38:39], v11 offset:43520
    ds_read_b128 v[52:55], v9 offset:672
    ds_read_b64_tr_b16 v[40:41], v11 offset:45056
    ds_read_b64_tr_b16 v[42:43], v11 offset:45568
    ds_read_b128 v[56:59], v9 offset:704
    ds_read_b64_tr_b16 v[44:45], v11 offset:47104
    ds_read_b64_tr_b16 v[46:47], v11 offset:47616
    ds_read_b128 v[60:63], v9 offset:736
    s_waitcnt lgkmcnt(0)
    v_mfma_f32_32x32x16_bf16 v[16:31], v[32:35], v[48:51], v[16:31]
    v_mfma_f32_32x32x16_bf16 v[16:31], v[36:39], v[52:55], v[16:31]
    v_mfma_f32_32x32x16_bf16 v[16:31], v[40:43], v[56:59], v[16:31]
    v_mfma_f32_32x32x16_bf16 v[16:31], v[44:47], v[60:63], v[16:31]
    ds_read_b64_tr_b16 v[32:33], v11 offset:49152
    ds_read_b64_tr_b16 v[34:35], v11 offset:49664
    ds_read_b128 v[48:51], v9 offset:768
    ds_read_b64_tr_b16 v[36:37], v11 offset:51200
    ds_read_b64_tr_b16 v[38:39], v11 offset:51712
    ds_read_b128 v[52:55], v9 offset:800
    ds_read_b64_tr_b16 v[40:41], v11 offset:53248
    ds_read_b64_tr_b16 v[42:43], v11 offset:53760
    ds_read_b128 v[56:59], v9 offset:832
    ds_read_b64_tr_b16 v[44:45], v11 offset:55296
    ds_read_b64_tr_b16 v[46:47], v11 offset:55808
    ds_read_b128 v[60:63], v9 offset:864
    s_waitcnt lgkmcnt(0)
    v_mfma_f32_32x32x16_bf16 v[16:31], v[32:35], v[48:51], v[16:31]
    v_mfma_f32_32x32x16_bf16 v[16:31], v[36:39], v[52:55], v[16:31]
    v_mfma_f32_32x32x16_bf16 v[16:31], v[40:43], v[56:59], v[16:31]
    v_mfma_f32_32x32x16_bf16 v[16:31], v[44:47], v[60:63], v[16:31]
    ds_read_b64_tr_b16 v[32:33], v11 offset:57344
    ds_read_b64_tr_b16 v[34:35], v11 offset:57856
    ds_read_b128 v[48:51], v9 offset:896
    ds_read_b64_tr_b16 v[36:37], v11 offset:59392
    ds_read_b64_tr_b16 v[38:39], v11 offset:59904
    ds_read_b128 v[52:55], v9 offset:928
    ds_read_b64_tr_b16 v[40:41], v11 offset:61440
    ds_read_b64_tr_b16 v[42:43], v11 offset:61952
    ds_read_b128 v[56:59], v9 offset:960
    ds_read_b64_tr_b16 v[44:45], v11 offset:63488
    ds_read_b64_tr_b16 v[46:47], v11 offset:64000
    ds_read_b128 v[60:63], v9 offset:992
    s_waitcnt lgkmcnt(0)
    v_mfma_f32_32x32x16_bf16 v[16:31], v[32:35], v[48:51], v[16:31]
    v_mfma_f32_32x32x16_bf16 v[16:31], v[36:39], v[52:55], v[16:31]
    v_mfma_f32_32x32x16_bf16 v[16:31], v[40:43], v[56:59], v[16:31]
    v_mfma_f32_32x32x16_bf16 v[16:31], v[44:47], v[60:63], v[16:31]
    s_nop 15
    s_nop 3
    s_lshl_b32 s62, s21, 7
    s_lshl_b32 s63, s19, 6
    s_add_u32 s62, s62, s63
    v_lshlrev_b32 v12, 10, v8
    v_lshl_add_u32 v12, v10, 3, v12
    v_add_u32 v12, s62, v12
    v_add_u32 v12, 2097152, v12
    s_mov_b32 s62, 0x3eb8aa3b
    v_mul_f32 v16, s62, v16
    v_mul_f32 v17, s62, v17
    v_mul_f32 v18, s62, v18
    v_mul_f32 v19, s62, v19
    v_mul_f32 v20, s62, v20
    v_mul_f32 v21, s62, v21
    v_mul_f32 v22, s62, v22
    v_mul_f32 v23, s62, v23
    v_mul_f32 v24, s62, v24
    v_mul_f32 v25, s62, v25
    v_mul_f32 v26, s62, v26
    v_mul_f32 v27, s62, v27
    v_mul_f32 v28, s62, v28
    v_mul_f32 v29, s62, v29
    v_mul_f32 v30, s62, v30
    v_mul_f32 v31, s62, v31
    v_cvt_pk_bf16_f32 v32, v16, v17
    v_cvt_pk_bf16_f32 v33, v18, v19
    buffer_store_dwordx2 v[32:33], v12, s[36:39], 0 offen offset:0
    v_cvt_pk_bf16_f32 v34, v20, v21
    v_cvt_pk_bf16_f32 v35, v22, v23
    buffer_store_dwordx2 v[34:35], v12, s[36:39], 0 offen offset:16
    v_cvt_pk_bf16_f32 v36, v24, v25
    v_cvt_pk_bf16_f32 v37, v26, v27
    buffer_store_dwordx2 v[36:37], v12, s[36:39], 0 offen offset:32
    v_cvt_pk_bf16_f32 v38, v28, v29
    v_cvt_pk_bf16_f32 v39, v30, v31
    buffer_store_dwordx2 v[38:39], v12, s[36:39], 0 offen offset:48
    s_and_b32 s62, s20, 7
    s_cmp_lg_u32 s62, s21
    s_cbranch_scc1 K1_END
    s_barrier
    v_lshlrev_b32 v2, 4, v1
    s_lshl_b32 s60, s22, 12
    s_add_u32 s61, s60, 66560
    s_mov_b32 m0, s61
    s_nop 0
    buffer_load_dwordx4 v2, s[32:35], s60 offen lds
    s_add_u32 s62, s61, 16384
    s_mov_b32 m0, s62
    s_nop 0
    buffer_load_dwordx4 v2, s[44:47], s60 offen lds
    s_add_u32 s60, s60, 1024
    s_add_u32 s61, s61, 1024
    s_mov_b32 m0, s61
    s_nop 0
    buffer_load_dwordx4 v2, s[32:35], s60 offen lds
    s_add_u32 s62, s61, 16384
    s_mov_b32 m0, s62
    s_nop 0
    buffer_load_dwordx4 v2, s[44:47], s60 offen lds
    s_add_u32 s60, s60, 1024
    s_add_u32 s61, s61, 1024
    s_mov_b32 m0, s61
    s_nop 0
    buffer_load_dwordx4 v2, s[32:35], s60 offen lds
    s_add_u32 s62, s61, 16384
    s_mov_b32 m0, s62
    s_nop 0
    buffer_load_dwordx4 v2, s[44:47], s60 offen lds
    s_add_u32 s60, s60, 1024
    s_add_u32 s61, s61, 1024
    s_mov_b32 m0, s61
    s_nop 0
    buffer_load_dwordx4 v2, s[32:35], s60 offen lds
    s_add_u32 s62, s61, 16384
    s_mov_b32 m0, s62
    s_nop 0
    buffer_load_dwordx4 v2, s[44:47], s60 offen lds
    s_add_u32 s60, s60, 1024
    s_add_u32 s61, s61, 1024
    s_waitcnt vmcnt(0)
    s_barrier
K1_KV:
    s_cmp_lg_u32 s19, 0
    s_cbranch_scc1 K1_END
    v_lshrrev_b32 v12, 5, v1
    v_lshlrev_b32 v11, 8, v12
    v_bfe_u32 v12, v1, 2, 2
    v_lshl_add_u32 v11, v12, 5, v11
    v_bfe_u32 v12, v1, 4, 1
    v_lshl_add_u32 v11, v12, 14, v11
    v_and_b32 v12, 3, v1
    v_lshl_add_u32 v11, v12, 3, v11
    v_add_u32 v11, 66560, v11
    v_mov_b32 v16, 0
    v_mov_b32 v17, 0
    v_mov_b32 v18, 0
    v_mov_b32 v19, 0
    v_mov_b32 v20, 0
    v_mov_b32 v21, 0
    v_mov_b32 v22, 0
    v_mov_b32 v23, 0
    v_mov_b32 v24, 0
    v_mov_b32 v25, 0
    v_mov_b32 v26, 0
    v_mov_b32 v27, 0
    v_mov_b32 v28, 0
    v_mov_b32 v29, 0
    v_mov_b32 v30, 0
    v_mov_b32 v31, 0
    ds_read_b64_tr_b16 v[32:33], v11 offset:0
    ds_read_b64_tr_b16 v[34:35], v11 offset:128
    ds_read_b128 v[48:51], v9 offset:0
    ds_read_b64_tr_b16 v[36:37], v11 offset:512
    ds_read_b64_tr_b16 v[38:39], v11 offset:640
    ds_read_b128 v[52:55], v9 offset:32
    ds_read_b64_tr_b16 v[40:41], v11 offset:1024
    ds_read_b64_tr_b16 v[42:43], v11 offset:1152
    ds_read_b128 v[56:59], v9 offset:64
    ds_read_b64_tr_b16 v[44:45], v11 offset:1536
    ds_read_b64_tr_b16 v[46:47], v11 offset:1664
    ds_read_b128 v[60:63], v9 offset:96
    s_waitcnt lgkmcnt(0)
    v_mfma_f32_32x32x16_bf16 v[16:31], v[32:35], v[48:51], v[16:31]
    v_mfma_f32_32x32x16_bf16 v[16:31], v[36:39], v[52:55], v[16:31]
    v_mfma_f32_32x32x16_bf16 v[16:31], v[40:43], v[56:59], v[16:31]
    v_mfma_f32_32x32x16_bf16 v[16:31], v[44:47], v[60:63], v[16:31]
    ds_read_b64_tr_b16 v[32:33], v11 offset:2048
    ds_read_b64_tr_b16 v[34:35], v11 offset:2176
    ds_read_b128 v[48:51], v9 offset:128
    ds_read_b64_tr_b16 v[36:37], v11 offset:2560
    ds_read_b64_tr_b16 v[38:39], v11 offset:2688
    ds_read_b128 v[52:55], v9 offset:160
    ds_read_b64_tr_b16 v[40:41], v11 offset:3072
    ds_read_b64_tr_b16 v[42:43], v11 offset:3200
    ds_read_b128 v[56:59], v9 offset:192
    ds_read_b64_tr_b16 v[44:45], v11 offset:3584
    ds_read_b64_tr_b16 v[46:47], v11 offset:3712
    ds_read_b128 v[60:63], v9 offset:224
    s_waitcnt lgkmcnt(0)
    v_mfma_f32_32x32x16_bf16 v[16:31], v[32:35], v[48:51], v[16:31]
    v_mfma_f32_32x32x16_bf16 v[16:31], v[36:39], v[52:55], v[16:31]
    v_mfma_f32_32x32x16_bf16 v[16:31], v[40:43], v[56:59], v[16:31]
    v_mfma_f32_32x32x16_bf16 v[16:31], v[44:47], v[60:63], v[16:31]
    ds_read_b64_tr_b16 v[32:33], v11 offset:4096
    ds_read_b64_tr_b16 v[34:35], v11 offset:4224
    ds_read_b128 v[48:51], v9 offset:256
    ds_read_b64_tr_b16 v[36:37], v11 offset:4608
    ds_read_b64_tr_b16 v[38:39], v11 offset:4736
    ds_read_b128 v[52:55], v9 offset:288
    ds_read_b64_tr_b16 v[40:41], v11 offset:5120
    ds_read_b64_tr_b16 v[42:43], v11 offset:5248
    ds_read_b128 v[56:59], v9 offset:320
    ds_read_b64_tr_b16 v[44:45], v11 offset:5632
    ds_read_b64_tr_b16 v[46:47], v11 offset:5760
    ds_read_b128 v[60:63], v9 offset:352
    s_waitcnt lgkmcnt(0)
    v_mfma_f32_32x32x16_bf16 v[16:31], v[32:35], v[48:51], v[16:31]
    v_mfma_f32_32x32x16_bf16 v[16:31], v[36:39], v[52:55], v[16:31]
    v_mfma_f32_32x32x16_bf16 v[16:31], v[40:43], v[56:59], v[16:31]
    v_mfma_f32_32x32x16_bf16 v[16:31], v[44:47], v[60:63], v[16:31]
    ds_read_b64_tr_b16 v[32:33], v11 offset:6144
    ds_read_b64_tr_b16 v[34:35], v11 offset:6272
    ds_read_b128 v[48:51], v9 offset:384
    ds_read_b64_tr_b16 v[36:37], v11 offset:6656
    ds_read_b64_tr_b16 v[38:39], v11 offset:6784
    ds_read_b128 v[52:55], v9 offset:416
    ds_read_b64_tr_b16 v[40:41], v11 offset:7168
    ds_read_b64_tr_b16 v[42:43], v11 offset:7296
    ds_read_b128 v[56:59], v9 offset:448
    ds_read_b64_tr_b16 v[44:45], v11 offset:7680
    ds_read_b64_tr_b16 v[46:47], v11 offset:7808
    ds_read_b128 v[60:63], v9 offset:480
    s_waitcnt lgkmcnt(0)
    v_mfma_f32_32x32x16_bf16 v[16:31], v[32:35], v[48:51], v[16:31]
    v_mfma_f32_32x32x16_bf16 v[16:31], v[36:39], v[52:55], v[16:31]
    v_mfma_f32_32x32x16_bf16 v[16:31], v[40:43], v[56:59], v[16:31]
    v_mfma_f32_32x32x16_bf16 v[16:31], v[44:47], v[60:63], v[16:31]
    ds_read_b64_tr_b16 v[32:33], v11 offset:8192
    ds_read_b64_tr_b16 v[34:35], v11 offset:8320
    ds_read_b128 v[48:51], v9 offset:512
    ds_read_b64_tr_b16 v[36:37], v11 offset:8704
    ds_read_b64_tr_b16 v[38:39], v11 offset:8832
    ds_read_b128 v[52:55], v9 offset:544
    ds_read_b64_tr_b16 v[40:41], v11 offset:9216
    ds_read_b64_tr_b16 v[42:43], v11 offset:9344
    ds_read_b128 v[56:59], v9 offset:576
    ds_read_b64_tr_b16 v[44:45], v11 offset:9728
    ds_read_b64_tr_b16 v[46:47], v11 offset:9856
    ds_read_b128 v[60:63], v9 offset:608
    s_waitcnt lgkmcnt(0)
    v_mfma_f32_32x32x16_bf16 v[16:31], v[32:35], v[48:51], v[16:31]
    v_mfma_f32_32x32x16_bf16 v[16:31], v[36:39], v[52:55], v[16:31]
    v_mfma_f32_32x32x16_bf16 v[16:31], v[40:43], v[56:59], v[16:31]
    v_mfma_f32_32x32x16_bf16 v[16:31], v[44:47], v[60:63], v[16:31]
    ds_read_b64_tr_b16 v[32:33], v11 offset:10240
    ds_read_b64_tr_b16 v[34:35], v11 offset:10368
    ds_read_b128 v[48:51], v9 offset:640
    ds_read_b64_tr_b16 v[36:37], v11 offset:10752
    ds_read_b64_tr_b16 v[38:39], v11 offset:10880
    ds_read_b128 v[52:55], v9 offset:672
    ds_read_b64_tr_b16 v[40:41], v11 offset:11264
    ds_read_b64_tr_b16 v[42:43], v11 offset:11392
    ds_read_b128 v[56:59], v9 offset:704
    ds_read_b64_tr_b16 v[44:45], v11 offset:11776
    ds_read_b64_tr_b16 v[46:47], v11 offset:11904
    ds_read_b128 v[60:63], v9 offset:736
    s_waitcnt lgkmcnt(0)
    v_mfma_f32_32x32x16_bf16 v[16:31], v[32:35], v[48:51], v[16:31]
    v_mfma_f32_32x32x16_bf16 v[16:31], v[36:39], v[52:55], v[16:31]
    v_mfma_f32_32x32x16_bf16 v[16:31], v[40:43], v[56:59], v[16:31]
    v_mfma_f32_32x32x16_bf16 v[16:31], v[44:47], v[60:63], v[16:31]
    ds_read_b64_tr_b16 v[32:33], v11 offset:12288
    ds_read_b64_tr_b16 v[34:35], v11 offset:12416
    ds_read_b128 v[48:51], v9 offset:768
    ds_read_b64_tr_b16 v[36:37], v11 offset:12800
    ds_read_b64_tr_b16 v[38:39], v11 offset:12928
    ds_read_b128 v[52:55], v9 offset:800
    ds_read_b64_tr_b16 v[40:41], v11 offset:13312
    ds_read_b64_tr_b16 v[42:43], v11 offset:13440
    ds_read_b128 v[56:59], v9 offset:832
    ds_read_b64_tr_b16 v[44:45], v11 offset:13824
    ds_read_b64_tr_b16 v[46:47], v11 offset:13952
    ds_read_b128 v[60:63], v9 offset:864
    s_waitcnt lgkmcnt(0)
    v_mfma_f32_32x32x16_bf16 v[16:31], v[32:35], v[48:51], v[16:31]
    v_mfma_f32_32x32x16_bf16 v[16:31], v[36:39], v[52:55], v[16:31]
    v_mfma_f32_32x32x16_bf16 v[16:31], v[40:43], v[56:59], v[16:31]
    v_mfma_f32_32x32x16_bf16 v[16:31], v[44:47], v[60:63], v[16:31]
    ds_read_b64_tr_b16 v[32:33], v11 offset:14336
    ds_read_b64_tr_b16 v[34:35], v11 offset:14464
    ds_read_b128 v[48:51], v9 offset:896
    ds_read_b64_tr_b16 v[36:37], v11 offset:14848
    ds_read_b64_tr_b16 v[38:39], v11 offset:14976
    ds_read_b128 v[52:55], v9 offset:928
    ds_read_b64_tr_b16 v[40:41], v11 offset:15360
    ds_read_b64_tr_b16 v[42:43], v11 offset:15488
    ds_read_b128 v[56:59], v9 offset:960
    ds_read_b64_tr_b16 v[44:45], v11 offset:15872
    ds_read_b64_tr_b16 v[46:47], v11 offset:16000
    ds_read_b128 v[60:63], v9 offset:992
    s_waitcnt lgkmcnt(0)
    v_mfma_f32_32x32x16_bf16 v[16:31], v[32:35], v[48:51], v[16:31]
    v_mfma_f32_32x32x16_bf16 v[16:31], v[36:39], v[52:55], v[16:31]
    v_mfma_f32_32x32x16_bf16 v[16:31], v[40:43], v[56:59], v[16:31]
    v_mfma_f32_32x32x16_bf16 v[16:31], v[44:47], v[60:63], v[16:31]
    s_nop 15
    s_nop 3
    v_lshlrev_b32 v12, 5, v8
    v_lshl_add_u32 v12, v10, 3, v12
    v_add_u32 v12, 4194304, v12
    v_cvt_pk_bf16_f32 v32, v16, v17
    v_cvt_pk_bf16_f32 v33, v18, v19
    buffer_store_dwordx2 v[32:33], v12, s[36:39], 0 offen offset:0
    v_cvt_pk_bf16_f32 v34, v20, v21
    v_cvt_pk_bf16_f32 v35, v22, v23
    buffer_store_dwordx2 v[34:35], v12, s[36:39], 0 offen offset:16
    v_lshrrev_b32 v12, 4, v8
    v_lshlrev_b32 v12, 9, v12
    v_bfe_u32 v13, v8, 2, 1
    v_lshl_add_u32 v12, v13, 8, v12
    v_bfe_u32 v13, v8, 3, 1
    v_lshl_add_u32 v12, v13, 3, v12
    v_and_b32 v13, 3, v8
    v_lshl_add_u32 v12, v13, 1, v12
    v_lshl_add_u32 v12, v10, 6, v12
    v_add_u32 v12, 4259840, v12
    v_cvt_pk_bf16_f32 v13, v24, v24
    buffer_store_short v13, v12, s[36:39], 0 offen offset:0
    v_cvt_pk_bf16_f32 v13, v25, v25
    buffer_store_short v13, v12, s[36:39], 0 offen offset:16
    v_cvt_pk_bf16_f32 v13, v26, v26
    buffer_store_short v13, v12, s[36:39], 0 offen offset:32
    v_cvt_pk_bf16_f32 v13, v27, v27
    buffer_store_short v13, v12, s[36:39], 0 offen offset:48
    v_cvt_pk_bf16_f32 v13, v28, v28
    buffer_store_short v13, v12, s[36:39], 0 offen offset:128
    v_cvt_pk_bf16_f32 v13, v29, v29
    buffer_store_short v13, v12, s[36:39], 0 offen offset:144
    v_cvt_pk_bf16_f32 v13, v30, v30
    buffer_store_short v13, v12, s[36:39], 0 offen offset:160
    v_cvt_pk_bf16_f32 v13, v31, v31
    buffer_store_short v13, v12, s[36:39], 0 offen offset:176
K1_END:
    s_endpgm
.globl attn_kernel
.p2align 8
.type attn_kernel,@function
attn_kernel:
    s_cmp_ge_u32 s2, 299
    s_cbranch_scc1 K2_END
    s_load_dwordx2 s[14:15], s[0:1], 96
    s_load_dwordx4 s[4:7], s[0:1], 56
    s_load_dwordx2 s[8:9], s[0:1], 72
    v_and_b32 v1, 63, v0
    v_lshrrev_b32 v2, 6, v0
    s_nop 0
    v_readfirstlane_b32 s22, v2
    s_mov_b32 s64, 0x0000ffff
    s_mov_b32 s65, 0x0000ffff
    s_waitcnt lgkmcnt(0)
    s_mov_b32 s36, s14
    s_and_b32 s37, s15, 0xffff
    s_mov_b32 s38, 0x800000
    s_mov_b32 s39, 0x00020000
    s_cmp_lt_u32 s2, 43
    s_cbranch_scc1 K2_MOE
    s_sub_u32 s20, s2, 43
    v_lshlrev_b32 v2, 4, v1
    s_lshl_b32 s60, s20, 3
    s_and_b32 s67, s22, 7
    s_add_u32 s60, s60, s67
    s_lshr_b32 s68, s22, 3
    s_lshl_b32 s69, s68, 15
    v_and_b32 v2, 31, v1
    v_lshrrev_b32 v3, 5, v1
    v_lshlrev_b32 v120, 5, v2
    v_lshl_add_u32 v120, v3, 4, v120
    s_lshl_b32 s61, s60, 10
    s_add_u32 s61, s61, 2097152
    buffer_load_dwordx4 v[4:7], v120, s[36:39], s61 offen
    v_lshlrev_b32 v124, 4, v1
    s_lshr_b32 s71, s22, 2
    s_lshl_b32 s71, s71, 15
    s_and_b32 s70, s22, 3
    s_lshl_b32 s70, s70, 10
    s_add_u32 s71, s71, s70
    s_add_u32 s70, s71, 4194304
    s_mov_b32 m0, s71
    s_nop 0
    buffer_load_dwordx4 v124, s[36:39], s70 offen lds
    s_add_u32 s70, s70, 4096
    s_add_u32 s71, s71, 4096
    s_mov_b32 m0, s71
    s_nop 0
    buffer_load_dwordx4 v124, s[36:39], s70 offen lds
    s_add_u32 s70, s70, 4096
    s_add_u32 s71, s71, 4096
    s_mov_b32 m0, s71
    s_nop 0
    buffer_load_dwordx4 v124, s[36:39], s70 offen lds
    s_add_u32 s70, s70, 4096
    s_add_u32 s71, s71, 4096
    s_mov_b32 m0, s71
    s_nop 0
    buffer_load_dwordx4 v124, s[36:39], s70 offen lds
    s_add_u32 s70, s70, 4096
    s_add_u32 s71, s71, 4096
    s_mov_b32 m0, s71
    s_nop 0
    buffer_load_dwordx4 v124, s[36:39], s70 offen lds
    s_add_u32 s70, s70, 4096
    s_add_u32 s71, s71, 4096
    s_mov_b32 m0, s71
    s_nop 0
    buffer_load_dwordx4 v124, s[36:39], s70 offen lds
    s_add_u32 s70, s70, 4096
    s_add_u32 s71, s71, 4096
    s_mov_b32 m0, s71
    s_nop 0
    buffer_load_dwordx4 v124, s[36:39], s70 offen lds
    s_add_u32 s70, s70, 4096
    s_add_u32 s71, s71, 4096
    s_mov_b32 m0, s71
    s_nop 0
    buffer_load_dwordx4 v124, s[36:39], s70 offen lds
    s_add_u32 s70, s70, 4096
    s_add_u32 s71, s71, 4096
    v_and_b32 v121, 15, v1
    v_lshlrev_b32 v121, 4, v121
    v_lshl_add_u32 v121, v3, 8, v121
    v_add_u32 v121, 0x10000, v121
    v_cmp_eq_u32 vcc, 16, v2
    v_mov_b32 v122, 0x3f803f80
    s_nop 1
    v_cndmask_b32 v122, 0, v122, vcc
    v_mov_b32 v16, v122
    v_mov_b32 v17, v122
    v_mov_b32 v18, v122
    v_mov_b32 v19, v122
    v_mov_b32 v20, v122
    v_mov_b32 v21, v122
    v_mov_b32 v22, v122
    v_mov_b32 v23, v122
    v_mov_b32 v24, v122
    v_mov_b32 v25, v122
    v_mov_b32 v26, v122
    v_mov_b32 v27, v122
    v_mov_b32 v28, v122
    v_mov_b32 v29, v122
    v_mov_b32 v30, v122
    v_mov_b32 v31, v122
    v_mov_b32 v88, 0
    v_mov_b32 v89, 0
    v_mov_b32 v90, 0
    v_mov_b32 v91, 0
    v_mov_b32 v92, 0
    v_mov_b32 v93, 0
    v_mov_b32 v94, 0
    v_mov_b32 v95, 0
    v_mov_b32 v96, 0
    v_mov_b32 v97, 0
    v_mov_b32 v98, 0
    v_mov_b32 v99, 0
    v_mov_b32 v100, 0
    v_mov_b32 v101, 0
    v_mov_b32 v102, 0
    v_mov_b32 v103, 0
    v_mov_b32 v32, 0
    v_mov_b32 v33, 0
    v_mov_b32 v34, 0
    v_mov_b32 v35, 0
    v_mov_b32 v36, 0
    v_mov_b32 v37, 0
    v_mov_b32 v38, 0
    v_mov_b32 v39, 0
    v_mov_b32 v40, 0
    v_mov_b32 v41, 0
    v_mov_b32 v42, 0
    v_mov_b32 v43, 0
    v_mov_b32 v44, 0
    v_mov_b32 v45, 0
    v_mov_b32 v46, 0
    v_mov_b32 v47, 0
    s_waitcnt vmcnt(0)
    s_barrier
    v_add_u32 v120, s69, v120
    v_add_u32 v121, s69, v121
    ds_read_b128 v[8:11], v120
    ds_read_b128 v[12:15], v120 offset:1024
    s_mov_b64 exec, s[64:65]
    ds_read_b128 v[16:19], v121
    ds_read_b128 v[20:23], v121 offset:512
    s_mov_b64 exec, -1
    s_waitcnt lgkmcnt(0)
    v_mfma_f32_32x32x16_bf16 v[48:63], v[8:11], v[4:7], v[32:47]
    s_nop 15
    s_nop 3
    v_max3_f32 v104, v48, v49, v50
    v_max3_f32 v104, v104, v51, v52
    v_max3_f32 v104, v104, v53, v54
    v_max3_f32 v104, v104, v55, v56
    v_max3_f32 v104, v104, v57, v58
    v_max3_f32 v104, v104, v59, v60
    v_max3_f32 v104, v104, v61, v62
    v_max_f32 v104, v104, v63
    v_mov_b32 v105, v104
    s_nop 1
    v_permlane32_swap_b32 v104, v105
    s_nop 1
    v_max_f32 v104, v104, v105
    v_sub_f32 v48, v48, v104
    v_sub_f32 v49, v49, v104
    v_sub_f32 v50, v50, v104
    v_sub_f32 v51, v51, v104
    v_sub_f32 v52, v52, v104
    v_sub_f32 v53, v53, v104
    v_sub_f32 v54, v54, v104
    v_sub_f32 v55, v55, v104
    v_sub_f32 v56, v56, v104
    v_sub_f32 v57, v57, v104
    v_sub_f32 v58, v58, v104
    v_sub_f32 v59, v59, v104
    v_sub_f32 v60, v60, v104
    v_sub_f32 v61, v61, v104
    v_sub_f32 v62, v62, v104
    v_sub_f32 v63, v63, v104
    v_sub_f32 v32, 0, v104
    v_sub_f32 v33, 0, v104
    v_sub_f32 v34, 0, v104
    v_sub_f32 v35, 0, v104
    v_sub_f32 v36, 0, v104
    v_sub_f32 v37, 0, v104
    v_sub_f32 v38, 0, v104
    v_sub_f32 v39, 0, v104
    v_sub_f32 v40, 0, v104
    v_sub_f32 v41, 0, v104
    v_sub_f32 v42, 0, v104
    v_sub_f32 v43, 0, v104
    v_sub_f32 v44, 0, v104
    v_sub_f32 v45, 0, v104
    v_sub_f32 v46, 0, v104
    v_sub_f32 v47, 0, v104
    v_add_u32 v120, 2048, v120
    v_add_u32 v121, 1024, v121
    s_mov_b32 s66, 0
K2_LOOP:
    s_waitcnt lgkmcnt(2)
    v_mfma_f32_32x32x16_bf16 v[64:79], v[12:15], v[4:7], v[32:47]
    ds_read_b128 v[8:11], v120 offset:0
    v_exp_f32 v48, v48
    v_exp_f32 v49, v49
    v_exp_f32 v50, v50
    v_exp_f32 v51, v51
    v_exp_f32 v52, v52
    v_exp_f32 v53, v53
    v_exp_f32 v54, v54
    v_exp_f32 v55, v55
    v_exp_f32 v56, v56
    v_exp_f32 v57, v57
    v_exp_f32 v58, v58
    v_exp_f32 v59, v59
    v_exp_f32 v60, v60
    v_exp_f32 v61, v61
    v_exp_f32 v62, v62
    v_exp_f32 v63, v63
    s_nop 0
    v_cvt_pk_bf16_f32 v80, v48, v49
    v_cvt_pk_bf16_f32 v81, v50, v51
    v_cvt_pk_bf16_f32 v82, v52, v53
    v_cvt_pk_bf16_f32 v83, v54, v55
    v_cvt_pk_bf16_f32 v84, v56, v57
    v_cvt_pk_bf16_f32 v85, v58, v59
    v_cvt_pk_bf16_f32 v86, v60, v61
    v_cvt_pk_bf16_f32 v87, v62, v63
    s_waitcnt lgkmcnt(1)
    s_nop 0
    v_mfma_f32_32x32x16_bf16 v[88:103], v[16:19], v[80:83], v[88:103]
    v_mfma_f32_32x32x16_bf16 v[88:103], v[20:23], v[84:87], v[88:103]
    s_mov_b64 exec, s[64:65]
    ds_read_b128 v[24:27], v121 offset:0
    ds_read_b128 v[28:31], v121 offset:512
    s_mov_b64 exec, -1
    v_max3_f32 v104, v64, v65, v66
    v_max3_f32 v104, v104, v67, v68
    v_max3_f32 v104, v104, v69, v70
    v_max3_f32 v104, v104, v71, v72
    v_max3_f32 v104, v104, v73, v74
    v_max3_f32 v104, v104, v75, v76
    v_max3_f32 v104, v104, v77, v78
    v_max_f32 v104, v104, v79
    v_cmp_lt_f32 vcc, 0x42200000, v104
    s_nop 1
    s_cbranch_vccnz K2_SLOWA
K2_BACKA:
    s_waitcnt lgkmcnt(2)
    v_mfma_f32_32x32x16_bf16 v[48:63], v[8:11], v[4:7], v[32:47]
    ds_read_b128 v[12:15], v120 offset:1024
    v_exp_f32 v64, v64
    v_exp_f32 v65, v65
    v_exp_f32 v66, v66
    v_exp_f32 v67, v67
    v_exp_f32 v68, v68
    v_exp_f32 v69, v69
    v_exp_f32 v70, v70
    v_exp_f32 v71, v71
    v_exp_f32 v72, v72
    v_exp_f32 v73, v73
    v_exp_f32 v74, v74
    v_exp_f32 v75, v75
    v_exp_f32 v76, v76
    v_exp_f32 v77, v77
    v_exp_f32 v78, v78
    v_exp_f32 v79, v79
    s_nop 0
    v_cvt_pk_bf16_f32 v80, v64, v65
    v_cvt_pk_bf16_f32 v81, v66, v67
    v_cvt_pk_bf16_f32 v82, v68, v69
    v_cvt_pk_bf16_f32 v83, v70, v71
    v_cvt_pk_bf16_f32 v84, v72, v73
    v_cvt_pk_bf16_f32 v85, v74, v75
    v_cvt_pk_bf16_f32 v86, v76, v77
    v_cvt_pk_bf16_f32 v87, v78, v79
    s_waitcnt lgkmcnt(1)
    s_nop 0
    v_mfma_f32_32x32x16_bf16 v[88:103], v[24:27], v[80:83], v[88:103]
    v_mfma_f32_32x32x16_bf16 v[88:103], v[28:31], v[84:87], v[88:103]
    s_mov_b64 exec, s[64:65]
    ds_read_b128 v[16:19], v121 offset:1024
    ds_read_b128 v[20:23], v121 offset:1536
    s_mov_b64 exec, -1
    v_max3_f32 v104, v48, v49, v50
    v_max3_f32 v104, v104, v51, v52
    v_max3_f32 v104, v104, v53, v54
    v_max3_f32 v104, v104, v55, v56
    v_max3_f32 v104, v104, v57, v58
    v_max3_f32 v104, v104, v59, v60
    v_max3_f32 v104, v104, v61, v62
    v_max_f32 v104, v104, v63
    v_cmp_lt_f32 vcc, 0x42200000, v104
    s_nop 1
    s_cbranch_vccnz K2_SLOWB
K2_BACKB:
    v_add_u32 v120, 2048, v120
    v_add_u32 v121, 2048, v121
    s_add_u32 s66, s66, 1
    s_cmp_lt_u32 s66, 15
    s_cbranch_scc1 K2_LOOP
    s_waitcnt lgkmcnt(2)
    v_mfma_f32_32x32x16_bf16 v[64:79], v[12:15], v[4:7], v[32:47]
    ds_read_b128 v[8:11], v120 offset:0
    v_exp_f32 v48, v48
    v_exp_f32 v49, v49
    v_exp_f32 v50, v50
    v_exp_f32 v51, v51
    v_exp_f32 v52, v52
    v_exp_f32 v53, v53
    v_exp_f32 v54, v54
    v_exp_f32 v55, v55
    v_exp_f32 v56, v56
    v_exp_f32 v57, v57
    v_exp_f32 v58, v58
    v_exp_f32 v59, v59
    v_exp_f32 v60, v60
    v_exp_f32 v61, v61
    v_exp_f32 v62, v62
    v_exp_f32 v63, v63
    s_nop 0
    v_cvt_pk_bf16_f32 v80, v48, v49
    v_cvt_pk_bf16_f32 v81, v50, v51
    v_cvt_pk_bf16_f32 v82, v52, v53
    v_cvt_pk_bf16_f32 v83, v54, v55
    v_cvt_pk_bf16_f32 v84, v56, v57
    v_cvt_pk_bf16_f32 v85, v58, v59
    v_cvt_pk_bf16_f32 v86, v60, v61
    v_cvt_pk_bf16_f32 v87, v62, v63
    s_waitcnt lgkmcnt(1)
    s_nop 0
    v_mfma_f32_32x32x16_bf16 v[88:103], v[16:19], v[80:83], v[88:103]
    v_mfma_f32_32x32x16_bf16 v[88:103], v[20:23], v[84:87], v[88:103]
    s_mov_b64 exec, s[64:65]
    ds_read_b128 v[24:27], v121 offset:0
    ds_read_b128 v[28:31], v121 offset:512
    s_mov_b64 exec, -1
    v_max3_f32 v104, v64, v65, v66
    v_max3_f32 v104, v104, v67, v68
    v_max3_f32 v104, v104, v69, v70
    v_max3_f32 v104, v104, v71, v72
    v_max3_f32 v104, v104, v73, v74
    v_max3_f32 v104, v104, v75, v76
    v_max3_f32 v104, v104, v77, v78
    v_max_f32 v104, v104, v79
    v_cmp_lt_f32 vcc, 0x42200000, v104
    s_nop 1
    s_cbranch_vccnz K2_SLOWC
K2_BACKC:
    v_exp_f32 v64, v64
    v_exp_f32 v65, v65
    v_exp_f32 v66, v66
    v_exp_f32 v67, v67
    v_exp_f32 v68, v68
    v_exp_f32 v69, v69
    v_exp_f32 v70, v70
    v_exp_f32 v71, v71
    v_exp_f32 v72, v72
    v_exp_f32 v73, v73
    v_exp_f32 v74, v74
    v_exp_f32 v75, v75
    v_exp_f32 v76, v76
    v_exp_f32 v77, v77
    v_exp_f32 v78, v78
    v_exp_f32 v79, v79
    s_nop 0
    v_cvt_pk_bf16_f32 v80, v64, v65
    v_cvt_pk_bf16_f32 v81, v66, v67
    v_cvt_pk_bf16_f32 v82, v68, v69
    v_cvt_pk_bf16_f32 v83, v70, v71
    v_cvt_pk_bf16_f32 v84, v72, v73
    v_cvt_pk_bf16_f32 v85, v74, v75
    v_cvt_pk_bf16_f32 v86, v76, v77
    v_cvt_pk_bf16_f32 v87, v78, v79
    s_waitcnt lgkmcnt(0)
    s_nop 0
    v_mfma_f32_32x32x16_bf16 v[88:103], v[24:27], v[80:83], v[88:103]
    v_mfma_f32_32x32x16_bf16 v[88:103], v[28:31], v[84:87], v[88:103]
    s_nop 15
    s_nop 3
    s_barrier
    s_lshl_b32 s67, s67, 13
    v_lshlrev_b32 v123, 4, v1
    v_add_u32 v123, s67, v123
    s_cmp_eq_u32 s68, 0
    s_cbranch_scc1 K2_LOWER
    ds_write_b128 v123, v[88:91] offset:0
    ds_write_b128 v123, v[92:95] offset:1024
    ds_write_b128 v123, v[96:99] offset:2048
    ds_write_b128 v123, v[100:103] offset:3072
    ds_write_b32 v123, v32 offset:4096
    s_waitcnt lgkmcnt(0)
    s_barrier
    s_endpgm
K2_LOWER:
    s_barrier
    ds_read_b128 v[48:51], v123 offset:0
    ds_read_b128 v[52:55], v123 offset:1024
    ds_read_b128 v[56:59], v123 offset:2048
    ds_read_b128 v[60:63], v123 offset:3072
    ds_read_b32 v104, v123 offset:4096
    s_waitcnt lgkmcnt(0)
    v_min_f32 v105, v104, v32
    v_sub_f32 v104, v105, v104
    v_sub_f32 v105, v105, v32
    v_exp_f32 v104, v104
    v_exp_f32 v105, v105
    s_nop 0
    v_mul_f32 v88, v88, v105
    v_fmac_f32 v88, v48, v104
    v_mul_f32 v89, v89, v105
    v_fmac_f32 v89, v49, v104
    v_mul_f32 v90, v90, v105
    v_fmac_f32 v90, v50, v104
    v_mul_f32 v91, v91, v105
    v_fmac_f32 v91, v51, v104
    v_mul_f32 v92, v92, v105
    v_fmac_f32 v92, v52, v104
    v_mul_f32 v93, v93, v105
    v_fmac_f32 v93, v53, v104
    v_mul_f32 v94, v94, v105
    v_fmac_f32 v94, v54, v104
    v_mul_f32 v95, v95, v105
    v_fmac_f32 v95, v55, v104
    v_mul_f32 v96, v96, v105
    v_fmac_f32 v96, v56, v104
    v_mul_f32 v97, v97, v105
    v_fmac_f32 v97, v57, v104
    v_mul_f32 v98, v98, v105
    v_fmac_f32 v98, v58, v104
    v_mul_f32 v99, v99, v105
    v_fmac_f32 v99, v59, v104
    v_mul_f32 v100, v100, v105
    v_fmac_f32 v100, v60, v104
    v_mul_f32 v101, v101, v105
    v_fmac_f32 v101, v61, v104
    v_mul_f32 v102, v102, v105
    v_fmac_f32 v102, v62, v104
    v_mul_f32 v103, v103, v105
    v_fmac_f32 v103, v63, v104
    v_mov_b32 v104, v96
    v_mov_b32 v105, v96
    s_nop 1
    v_permlane32_swap_b32 v104, v105
    s_nop 1
    v_rcp_f32 v104, v104
    s_nop 0
    v_mul_f32 v88, v88, v104
    v_mul_f32 v89, v89, v104
    v_mul_f32 v90, v90, v104
    v_mul_f32 v91, v91, v104
    v_mul_f32 v92, v92, v104
    v_mul_f32 v93, v93, v104
    v_mul_f32 v94, v94, v104
    v_mul_f32 v95, v95, v104
    v_cvt_pk_bf16_f32 v80, v88, v89
    v_cvt_pk_bf16_f32 v81, v90, v91
    v_cvt_pk_bf16_f32 v82, v92, v93
    v_cvt_pk_bf16_f32 v83, v94, v95
    v_lshlrev_b32 v2, 5, v2
    v_lshl_add_u32 v2, v3, 3, v2
    s_lshl_b32 s61, s60, 10
    s_add_u32 s61, s61, 5242880
    buffer_store_dwordx2 v[80:81], v2, s[36:39], s61 offen
    buffer_store_dwordx2 v[82:83], v2, s[36:39], s61 offen offset:16
    s_endpgm
K2_SLOWA:
    s_nop 15
    s_nop 15
    v_mov_b32 v105, v104
    s_nop 1
    v_permlane32_swap_b32 v104, v105
    s_nop 1
    v_max_f32 v104, v104, v105
    v_max_f32 v104, 0, v104
    v_sub_f32 v64, v64, v104
    v_sub_f32 v65, v65, v104
    v_sub_f32 v66, v66, v104
    v_sub_f32 v67, v67, v104
    v_sub_f32 v68, v68, v104
    v_sub_f32 v69, v69, v104
    v_sub_f32 v70, v70, v104
    v_sub_f32 v71, v71, v104
    v_sub_f32 v72, v72, v104
    v_sub_f32 v73, v73, v104
    v_sub_f32 v74, v74, v104
    v_sub_f32 v75, v75, v104
    v_sub_f32 v76, v76, v104
    v_sub_f32 v77, v77, v104
    v_sub_f32 v78, v78, v104
    v_sub_f32 v79, v79, v104
    v_sub_f32 v32, v32, v104
    v_sub_f32 v33, v33, v104
    v_sub_f32 v34, v34, v104
    v_sub_f32 v35, v35, v104
    v_sub_f32 v36, v36, v104
    v_sub_f32 v37, v37, v104
    v_sub_f32 v38, v38, v104
    v_sub_f32 v39, v39, v104
    v_sub_f32 v40, v40, v104
    v_sub_f32 v41, v41, v104
    v_sub_f32 v42, v42, v104
    v_sub_f32 v43, v43, v104
    v_sub_f32 v44, v44, v104
    v_sub_f32 v45, v45, v104
    v_sub_f32 v46, v46, v104
    v_sub_f32 v47, v47, v104
    v_sub_f32 v104, 0, v104
    v_exp_f32 v104, v104
    s_nop 0
    v_mul_f32 v88, v88, v104
    v_mul_f32 v89, v89, v104
    v_mul_f32 v90, v90, v104
    v_mul_f32 v91, v91, v104
    v_mul_f32 v92, v92, v104
    v_mul_f32 v93, v93, v104
    v_mul_f32 v94, v94, v104
    v_mul_f32 v95, v95, v104
    v_mul_f32 v96, v96, v104
    v_mul_f32 v97, v97, v104
    v_mul_f32 v98, v98, v104
    v_mul_f32 v99, v99, v104
    v_mul_f32 v100, v100, v104
    v_mul_f32 v101, v101, v104
    v_mul_f32 v102, v102, v104
    v_mul_f32 v103, v103, v104
    s_nop 3
    s_branch K2_BACKA
K2_SLOWB:
    s_nop 15
    s_nop 15
    v_mov_b32 v105, v104
    s_nop 1
    v_permlane32_swap_b32 v104, v105
    s_nop 1
    v_max_f32 v104, v104, v105
    v_max_f32 v104, 0, v104
    v_sub_f32 v48, v48, v104
    v_sub_f32 v49, v49, v104
    v_sub_f32 v50, v50, v104
    v_sub_f32 v51, v51, v104
    v_sub_f32 v52, v52, v104
    v_sub_f32 v53, v53, v104
    v_sub_f32 v54, v54, v104
    v_sub_f32 v55, v55, v104
    v_sub_f32 v56, v56, v104
    v_sub_f32 v57, v57, v104
    v_sub_f32 v58, v58, v104
    v_sub_f32 v59, v59, v104
    v_sub_f32 v60, v60, v104
    v_sub_f32 v61, v61, v104
    v_sub_f32 v62, v62, v104
    v_sub_f32 v63, v63, v104
    v_sub_f32 v32, v32, v104
    v_sub_f32 v33, v33, v104
    v_sub_f32 v34, v34, v104
    v_sub_f32 v35, v35, v104
    v_sub_f32 v36, v36, v104
    v_sub_f32 v37, v37, v104
    v_sub_f32 v38, v38, v104
    v_sub_f32 v39, v39, v104
    v_sub_f32 v40, v40, v104
    v_sub_f32 v41, v41, v104
    v_sub_f32 v42, v42, v104
    v_sub_f32 v43, v43, v104
    v_sub_f32 v44, v44, v104
    v_sub_f32 v45, v45, v104
    v_sub_f32 v46, v46, v104
    v_sub_f32 v47, v47, v104
    v_sub_f32 v104, 0, v104
    v_exp_f32 v104, v104
    s_nop 0
    v_mul_f32 v88, v88, v104
    v_mul_f32 v89, v89, v104
    v_mul_f32 v90, v90, v104
    v_mul_f32 v91, v91, v104
    v_mul_f32 v92, v92, v104
    v_mul_f32 v93, v93, v104
    v_mul_f32 v94, v94, v104
    v_mul_f32 v95, v95, v104
    v_mul_f32 v96, v96, v104
    v_mul_f32 v97, v97, v104
    v_mul_f32 v98, v98, v104
    v_mul_f32 v99, v99, v104
    v_mul_f32 v100, v100, v104
    v_mul_f32 v101, v101, v104
    v_mul_f32 v102, v102, v104
    v_mul_f32 v103, v103, v104
    s_nop 3
    s_branch K2_BACKB
K2_SLOWC:
    s_nop 15
    s_nop 15
    v_mov_b32 v105, v104
    s_nop 1
    v_permlane32_swap_b32 v104, v105
    s_nop 1
    v_max_f32 v104, v104, v105
    v_max_f32 v104, 0, v104
    v_sub_f32 v64, v64, v104
    v_sub_f32 v65, v65, v104
    v_sub_f32 v66, v66, v104
    v_sub_f32 v67, v67, v104
    v_sub_f32 v68, v68, v104
    v_sub_f32 v69, v69, v104
    v_sub_f32 v70, v70, v104
    v_sub_f32 v71, v71, v104
    v_sub_f32 v72, v72, v104
    v_sub_f32 v73, v73, v104
    v_sub_f32 v74, v74, v104
    v_sub_f32 v75, v75, v104
    v_sub_f32 v76, v76, v104
    v_sub_f32 v77, v77, v104
    v_sub_f32 v78, v78, v104
    v_sub_f32 v79, v79, v104
    v_sub_f32 v32, v32, v104
    v_sub_f32 v33, v33, v104
    v_sub_f32 v34, v34, v104
    v_sub_f32 v35, v35, v104
    v_sub_f32 v36, v36, v104
    v_sub_f32 v37, v37, v104
    v_sub_f32 v38, v38, v104
    v_sub_f32 v39, v39, v104
    v_sub_f32 v40, v40, v104
    v_sub_f32 v41, v41, v104
    v_sub_f32 v42, v42, v104
    v_sub_f32 v43, v43, v104
    v_sub_f32 v44, v44, v104
    v_sub_f32 v45, v45, v104
    v_sub_f32 v46, v46, v104
    v_sub_f32 v47, v47, v104
    v_sub_f32 v104, 0, v104
    v_exp_f32 v104, v104
    s_nop 0
    v_mul_f32 v88, v88, v104
    v_mul_f32 v89, v89, v104
    v_mul_f32 v90, v90, v104
    v_mul_f32 v91, v91, v104
    v_mul_f32 v92, v92, v104
    v_mul_f32 v93, v93, v104
    v_mul_f32 v94, v94, v104
    v_mul_f32 v95, v95, v104
    v_mul_f32 v96, v96, v104
    v_mul_f32 v97, v97, v104
    v_mul_f32 v98, v98, v104
    v_mul_f32 v99, v99, v104
    v_mul_f32 v100, v100, v104
    v_mul_f32 v101, v101, v104
    v_mul_f32 v102, v102, v104
    v_mul_f32 v103, v103, v104
    s_nop 3
    s_branch K2_BACKC
K2_MOE:
    s_cmp_lt_u32 s22, 8
    s_cbranch_scc1 K2_MOE_GO
    s_barrier
    s_barrier
    s_barrier
    s_barrier
    s_endpgm
K2_MOE_GO:
    s_mov_b32 s24, s4
    s_and_b32 s25, s5, 0xffff
    s_mov_b32 s26, 0x158000
    s_mov_b32 s27, 0x00020000
    s_mov_b32 s28, s6
    s_and_b32 s29, s7, 0xffff
    s_mov_b32 s30, 0x158000
    s_mov_b32 s31, 0x00020000
    s_mov_b32 s32, s8
    s_and_b32 s33, s9, 0xffff
    s_mov_b32 s34, 0x158000
    s_mov_b32 s35, 0x00020000
    v_lshrrev_b32 v2, 2, v1
    v_mul_u32_u24 v2, 2752, v2
    v_and_b32 v3, 3, v1
    v_lshl_add_u32 v2, v3, 4, v2
    v_lshlrev_b32 v3, 4, v1
    s_lshl_b32 s60, s2, 6
    s_mul_i32 s61, s22, 176128
    s_add_u32 s60, s60, s61
    s_lshl_b32 s61, s22, 12
    s_lshl_b32 s62, s2, 15
    s_add_u32 s62, s62, s61
    s_mov_b32 m0, s61
    s_nop 0
    buffer_load_dwordx4 v2, s[24:27], s60 offen lds
    s_add_u32 s63, s61, 32768
    s_mov_b32 m0, s63
    s_nop 0
    buffer_load_dwordx4 v2, s[28:31], s60 offen lds
    s_add_u32 s63, s61, 65536
    s_mov_b32 m0, s63
    s_nop 0
    buffer_load_dwordx4 v3, s[32:35], s62 offen lds
    s_add_u32 s60, s60, 44032
    s_add_u32 s61, s61, 1024
    s_add_u32 s62, s62, 1024
    s_mov_b32 m0, s61
    s_nop 0
    buffer_load_dwordx4 v2, s[24:27], s60 offen lds
    s_add_u32 s63, s61, 32768
    s_mov_b32 m0, s63
    s_nop 0
    buffer_load_dwordx4 v2, s[28:31], s60 offen lds
    s_add_u32 s63, s61, 65536
    s_mov_b32 m0, s63
    s_nop 0
    buffer_load_dwordx4 v3, s[32:35], s62 offen lds
    s_add_u32 s60, s60, 44032
    s_add_u32 s61, s61, 1024
    s_add_u32 s62, s62, 1024
    s_mov_b32 m0, s61
    s_nop 0
    buffer_load_dwordx4 v2, s[24:27], s60 offen lds
    s_add_u32 s63, s61, 32768
    s_mov_b32 m0, s63
    s_nop 0
    buffer_load_dwordx4 v2, s[28:31], s60 offen lds
    s_add_u32 s63, s61, 65536
    s_mov_b32 m0, s63
    s_nop 0
    buffer_load_dwordx4 v3, s[32:35], s62 offen lds
    s_add_u32 s60, s60, 44032
    s_add_u32 s61, s61, 1024
    s_add_u32 s62, s62, 1024
    s_mov_b32 m0, s61
    s_nop 0
    buffer_load_dwordx4 v2, s[24:27], s60 offen lds
    s_add_u32 s63, s61, 32768
    s_mov_b32 m0, s63
    s_nop 0
    buffer_load_dwordx4 v2, s[28:31], s60 offen lds
    s_add_u32 s63, s61, 65536
    s_mov_b32 m0, s63
    s_nop 0
    buffer_load_dwordx4 v3, s[32:35], s62 offen lds
    s_add_u32 s60, s60, 44032
    s_add_u32 s61, s61, 1024
    s_add_u32 s62, s62, 1024
    v_add_u32 v4, 4325376, v3
    s_movk_i32 s47, 4096
    buffer_load_dwordx4 v[8:11], v4, s[36:39], 0 offen offset:0
    buffer_load_dwordx4 v[12:15], v4, s[36:39], 0 offen offset:1024
    buffer_load_dwordx4 v[16:19], v4, s[36:39], 0 offen offset:2048
    buffer_load_dwordx4 v[20:23], v4, s[36:39], 0 offen offset:3072
    buffer_load_dwordx4 v[24:27], v4, s[36:39], s47 offen offset:0
    buffer_load_dwordx4 v[28:31], v4, s[36:39], s47 offen offset:1024
    buffer_load_dwordx4 v[32:35], v4, s[36:39], s47 offen offset:2048
    buffer_load_dwordx4 v[36:39], v4, s[36:39], s47 offen offset:3072
    v_mov_b32 v5, 0
    v_mov_b32 v6, 0
    v_lshlrev_b32 v7, 2, v1
    v_sub_u32 v7, 2047, v7
    s_waitcnt vmcnt(0)
    v_ashrrev_i32 v40, 31, v8
    v_or_b32 v40, 0x80000000, v40
    v_xor_b32 v40, v40, v8
    v_and_b32 v40, 0xffff0000, v40
    v_subrev_u32 v41, 0, v7
    v_or_b32 v40, v40, v41
    v_min_u32 v41, v5, v40
    v_max_u32 v6, v6, v41
    v_max_u32 v5, v5, v40
    v_ashrrev_i32 v40, 31, v9
    v_or_b32 v40, 0x80000000, v40
    v_xor_b32 v40, v40, v9
    v_and_b32 v40, 0xffff0000, v40
    v_subrev_u32 v41, 1, v7
    v_or_b32 v40, v40, v41
    v_min_u32 v41, v5, v40
    v_max_u32 v6, v6, v41
    v_max_u32 v5, v5, v40
    v_ashrrev_i32 v40, 31, v10
    v_or_b32 v40, 0x80000000, v40
    v_xor_b32 v40, v40, v10
    v_and_b32 v40, 0xffff0000, v40
    v_subrev_u32 v41, 2, v7
    v_or_b32 v40, v40, v41
    v_min_u32 v41, v5, v40
    v_max_u32 v6, v6, v41
    v_max_u32 v5, v5, v40
    v_ashrrev_i32 v40, 31, v11
    v_or_b32 v40, 0x80000000, v40
    v_xor_b32 v40, v40, v11
    v_and_b32 v40, 0xffff0000, v40
    v_subrev_u32 v41, 3, v7
    v_or_b32 v40, v40, v41
    v_min_u32 v41, v5, v40
    v_max_u32 v6, v6, v41
    v_max_u32 v5, v5, v40
    v_ashrrev_i32 v40, 31, v12
    v_or_b32 v40, 0x80000000, v40
    v_xor_b32 v40, v40, v12
    v_and_b32 v40, 0xffff0000, v40
    v_subrev_u32 v41, 256, v7
    v_or_b32 v40, v40, v41
    v_min_u32 v41, v5, v40
    v_max_u32 v6, v6, v41
    v_max_u32 v5, v5, v40
    v_ashrrev_i32 v40, 31, v13
    v_or_b32 v40, 0x80000000, v40
    v_xor_b32 v40, v40, v13
    v_and_b32 v40, 0xffff0000, v40
    v_subrev_u32 v41, 257, v7
    v_or_b32 v40, v40, v41
    v_min_u32 v41, v5, v40
    v_max_u32 v6, v6, v41
    v_max_u32 v5, v5, v40
    v_ashrrev_i32 v40, 31, v14
    v_or_b32 v40, 0x80000000, v40
    v_xor_b32 v40, v40, v14
    v_and_b32 v40, 0xffff0000, v40
    v_subrev_u32 v41, 258, v7
    v_or_b32 v40, v40, v41
    v_min_u32 v41, v5, v40
    v_max_u32 v6, v6, v41
    v_max_u32 v5, v5, v40
    v_ashrrev_i32 v40, 31, v15
    v_or_b32 v40, 0x80000000, v40
    v_xor_b32 v40, v40, v15
    v_and_b32 v40, 0xffff0000, v40
    v_subrev_u32 v41, 259, v7
    v_or_b32 v40, v40, v41
    v_min_u32 v41, v5, v40
    v_max_u32 v6, v6, v41
    v_max_u32 v5, v5, v40
    v_ashrrev_i32 v40, 31, v16
    v_or_b32 v40, 0x80000000, v40
    v_xor_b32 v40, v40, v16
    v_and_b32 v40, 0xffff0000, v40
    v_subrev_u32 v41, 512, v7
    v_or_b32 v40, v40, v41
    v_min_u32 v41, v5, v40
    v_max_u32 v6, v6, v41
    v_max_u32 v5, v5, v40
    v_ashrrev_i32 v40, 31, v17
    v_or_b32 v40, 0x80000000, v40
    v_xor_b32 v40, v40, v17
    v_and_b32 v40, 0xffff0000, v40
    v_subrev_u32 v41, 513, v7
    v_or_b32 v40, v40, v41
    v_min_u32 v41, v5, v40
    v_max_u32 v6, v6, v41
    v_max_u32 v5, v5, v40
    v_ashrrev_i32 v40, 31, v18
    v_or_b32 v40, 0x80000000, v40
    v_xor_b32 v40, v40, v18
    v_and_b32 v40, 0xffff0000, v40
    v_subrev_u32 v41, 514, v7
    v_or_b32 v40, v40, v41
    v_min_u32 v41, v5, v40
    v_max_u32 v6, v6, v41
    v_max_u32 v5, v5, v40
    v_ashrrev_i32 v40, 31, v19
    v_or_b32 v40, 0x80000000, v40
    v_xor_b32 v40, v40, v19
    v_and_b32 v40, 0xffff0000, v40
    v_subrev_u32 v41, 515, v7
    v_or_b32 v40, v40, v41
    v_min_u32 v41, v5, v40
    v_max_u32 v6, v6, v41
    v_max_u32 v5, v5, v40
    v_ashrrev_i32 v40, 31, v20
    v_or_b32 v40, 0x80000000, v40
    v_xor_b32 v40, v40, v20
    v_and_b32 v40, 0xffff0000, v40
    v_subrev_u32 v41, 768, v7
    v_or_b32 v40, v40, v41
    v_min_u32 v41, v5, v40
    v_max_u32 v6, v6, v41
    v_max_u32 v5, v5, v40
    v_ashrrev_i32 v40, 31, v21
    v_or_b32 v40, 0x80000000, v40
    v_xor_b32 v40, v40, v21
    v_and_b32 v40, 0xffff0000, v40
    v_subrev_u32 v41, 769, v7
    v_or_b32 v40, v40, v41
    v_min_u32 v41, v5, v40
    v_max_u32 v6, v6, v41
    v_max_u32 v5, v5, v40
    v_ashrrev_i32 v40, 31, v22
    v_or_b32 v40, 0x80000000, v40
    v_xor_b32 v40, v40, v22
    v_and_b32 v40, 0xffff0000, v40
    v_subrev_u32 v41, 770, v7
    v_or_b32 v40, v40, v41
    v_min_u32 v41, v5, v40
    v_max_u32 v6, v6, v41
    v_max_u32 v5, v5, v40
    v_ashrrev_i32 v40, 31, v23
    v_or_b32 v40, 0x80000000, v40
    v_xor_b32 v40, v40, v23
    v_and_b32 v40, 0xffff0000, v40
    v_subrev_u32 v41, 771, v7
    v_or_b32 v40, v40, v41
    v_min_u32 v41, v5, v40
    v_max_u32 v6, v6, v41
    v_max_u32 v5, v5, v40
    v_ashrrev_i32 v40, 31, v24
    v_or_b32 v40, 0x80000000, v40
    v_xor_b32 v40, v40, v24
    v_and_b32 v40, 0xffff0000, v40
    v_subrev_u32 v41, 1024, v7
    v_or_b32 v40, v40, v41
    v_min_u32 v41, v5, v40
    v_max_u32 v6, v6, v41
    v_max_u32 v5, v5, v40
    v_ashrrev_i32 v40, 31, v25
    v_or_b32 v40, 0x80000000, v40
    v_xor_b32 v40, v40, v25
    v_and_b32 v40, 0xffff0000, v40
    v_subrev_u32 v41, 1025, v7
    v_or_b32 v40, v40, v41
    v_min_u32 v41, v5, v40
    v_max_u32 v6, v6, v41
    v_max_u32 v5, v5, v40
    v_ashrrev_i32 v40, 31, v26
    v_or_b32 v40, 0x80000000, v40
    v_xor_b32 v40, v40, v26
    v_and_b32 v40, 0xffff0000, v40
    v_subrev_u32 v41, 1026, v7
    v_or_b32 v40, v40, v41
    v_min_u32 v41, v5, v40
    v_max_u32 v6, v6, v41
    v_max_u32 v5, v5, v40
    v_ashrrev_i32 v40, 31, v27
    v_or_b32 v40, 0x80000000, v40
    v_xor_b32 v40, v40, v27
    v_and_b32 v40, 0xffff0000, v40
    v_subrev_u32 v41, 1027, v7
    v_or_b32 v40, v40, v41
    v_min_u32 v41, v5, v40
    v_max_u32 v6, v6, v41
    v_max_u32 v5, v5, v40
    v_ashrrev_i32 v40, 31, v28
    v_or_b32 v40, 0x80000000, v40
    v_xor_b32 v40, v40, v28
    v_and_b32 v40, 0xffff0000, v40
    v_subrev_u32 v41, 1280, v7
    v_or_b32 v40, v40, v41
    v_min_u32 v41, v5, v40
    v_max_u32 v6, v6, v41
    v_max_u32 v5, v5, v40
    v_ashrrev_i32 v40, 31, v29
    v_or_b32 v40, 0x80000000, v40
    v_xor_b32 v40, v40, v29
    v_and_b32 v40, 0xffff0000, v40
    v_subrev_u32 v41, 1281, v7
    v_or_b32 v40, v40, v41
    v_min_u32 v41, v5, v40
    v_max_u32 v6, v6, v41
    v_max_u32 v5, v5, v40
    v_ashrrev_i32 v40, 31, v30
    v_or_b32 v40, 0x80000000, v40
    v_xor_b32 v40, v40, v30
    v_and_b32 v40, 0xffff0000, v40
    v_subrev_u32 v41, 1282, v7
    v_or_b32 v40, v40, v41
    v_min_u32 v41, v5, v40
    v_max_u32 v6, v6, v41
    v_max_u32 v5, v5, v40
    v_ashrrev_i32 v40, 31, v31
    v_or_b32 v40, 0x80000000, v40
    v_xor_b32 v40, v40, v31
    v_and_b32 v40, 0xffff0000, v40
    v_subrev_u32 v41, 1283, v7
    v_or_b32 v40, v40, v41
    v_min_u32 v41, v5, v40
    v_max_u32 v6, v6, v41
    v_max_u32 v5, v5, v40
    v_ashrrev_i32 v40, 31, v32
    v_or_b32 v40, 0x80000000, v40
    v_xor_b32 v40, v40, v32
    v_and_b32 v40, 0xffff0000, v40
    v_subrev_u32 v41, 1536, v7
    v_or_b32 v40, v40, v41
    v_min_u32 v41, v5, v40
    v_max_u32 v6, v6, v41
    v_max_u32 v5, v5, v40
    v_ashrrev_i32 v40, 31, v33
    v_or_b32 v40, 0x80000000, v40
    v_xor_b32 v40, v40, v33
    v_and_b32 v40, 0xffff0000, v40
    v_subrev_u32 v41, 1537, v7
    v_or_b32 v40, v40, v41
    v_min_u32 v41, v5, v40
    v_max_u32 v6, v6, v41
    v_max_u32 v5, v5, v40
    v_ashrrev_i32 v40, 31, v34
    v_or_b32 v40, 0x80000000, v40
    v_xor_b32 v40, v40, v34
    v_and_b32 v40, 0xffff0000, v40
    v_subrev_u32 v41, 1538, v7
    v_or_b32 v40, v40, v41
    v_min_u32 v41, v5, v40
    v_max_u32 v6, v6, v41
    v_max_u32 v5, v5, v40
    v_ashrrev_i32 v40, 31, v35
    v_or_b32 v40, 0x80000000, v40
    v_xor_b32 v40, v40, v35
    v_and_b32 v40, 0xffff0000, v40
    v_subrev_u32 v41, 1539, v7
    v_or_b32 v40, v40, v41
    v_min_u32 v41, v5, v40
    v_max_u32 v6, v6, v41
    v_max_u32 v5, v5, v40
    v_ashrrev_i32 v40, 31, v36
    v_or_b32 v40, 0x80000000, v40
    v_xor_b32 v40, v40, v36
    v_and_b32 v40, 0xffff0000, v40
    v_subrev_u32 v41, 1792, v7
    v_or_b32 v40, v40, v41
    v_min_u32 v41, v5, v40
    v_max_u32 v6, v6, v41
    v_max_u32 v5, v5, v40
    v_ashrrev_i32 v40, 31, v37
    v_or_b32 v40, 0x80000000, v40
    v_xor_b32 v40, v40, v37
    v_and_b32 v40, 0xffff0000, v40
    v_subrev_u32 v41, 1793, v7
    v_or_b32 v40, v40, v41
    v_min_u32 v41, v5, v40
    v_max_u32 v6, v6, v41
    v_max_u32 v5, v5, v40
    v_ashrrev_i32 v40, 31, v38
    v_or_b32 v40, 0x80000000, v40
    v_xor_b32 v40, v40, v38
    v_and_b32 v40, 0xffff0000, v40
    v_subrev_u32 v41, 1794, v7
    v_or_b32 v40, v40, v41
    v_min_u32 v41, v5, v40
    v_max_u32 v6, v6, v41
    v_max_u32 v5, v5, v40
    v_ashrrev_i32 v40, 31, v39
    v_or_b32 v40, 0x80000000, v40
    v_xor_b32 v40, v40, v39
    v_and_b32 v40, 0xffff0000, v40
    v_subrev_u32 v41, 1795, v7
    v_or_b32 v40, v40, v41
    v_min_u32 v41, v5, v40
    v_max_u32 v6, v6, v41
    v_max_u32 v5, v5, v40
    v_mov_b32 v42, v5
    s_nop 1
    v_max_u32_dpp v42, v42, v42 quad_perm:[1,0,3,2] row_mask:0xf bank_mask:0xf
    s_nop 1
    v_max_u32_dpp v42, v42, v42 quad_perm:[2,3,0,1] row_mask:0xf bank_mask:0xf
    s_nop 1
    v_max_u32_dpp v42, v42, v42 row_half_mirror row_mask:0xf bank_mask:0xf
    s_nop 1
    v_max_u32_dpp v42, v42, v42 row_mirror row_mask:0xf bank_mask:0xf
    ds_swizzle_b32 v43, v42 offset:0x401F
    s_waitcnt lgkmcnt(0)
    v_max_u32 v42, v42, v43
    v_mov_b32 v43, v42
    s_nop 1
    v_permlane32_swap_b32 v42, v43
    s_nop 1
    v_max_u32 v42, v42, v43
    v_cmp_eq_u32 vcc, v5, v42
    s_nop 1
    v_cndmask_b32 v5, v5, v6, vcc
    v_mov_b32 v44, v5
    s_nop 1
    v_max_u32_dpp v44, v44, v44 quad_perm:[1,0,3,2] row_mask:0xf bank_mask:0xf
    s_nop 1
    v_max_u32_dpp v44, v44, v44 quad_perm:[2,3,0,1] row_mask:0xf bank_mask:0xf
    s_nop 1
    v_max_u32_dpp v44, v44, v44 row_half_mirror row_mask:0xf bank_mask:0xf
    s_nop 1
    v_max_u32_dpp v44, v44, v44 row_mirror row_mask:0xf bank_mask:0xf
    ds_swizzle_b32 v45, v44 offset:0x401F
    s_waitcnt lgkmcnt(0)
    v_max_u32 v44, v44, v45
    v_mov_b32 v45, v44
    s_nop 1
    v_permlane32_swap_b32 v44, v45
    s_nop 1
    v_max_u32 v44, v44, v45
    s_nop 1
    v_readfirstlane_b32 s40, v42
    v_readfirstlane_b32 s41, v44
    s_nop 3
    s_and_b32 s42, s40, 0x7ff
    s_sub_u32 s42, 2047, s42
    s_and_b32 s43, s41, 0x7ff
    s_sub_u32 s43, 2047, s43
    s_and_b32 s44, s40, 0xffff0000
    v_mov_b32 v40, s44
    v_ashrrev_i32 v41, 31, v40
    v_not_b32 v41, v41
    v_or_b32 v41, 0x80000000, v41
    v_xor_b32 v40, v40, v41
    v_and_b32 v40, 0xffff0000, v40
    v_mul_f32 v40, 0xbfb8aa3b, v40
    v_exp_f32 v40, v40
    s_nop 0
    v_add_f32 v40, 1.0, v40
    v_rcp_f32 v40, v40
    s_nop 0
    v_cvt_pk_bf16_f32 v40, v40, v40
    v_lshlrev_b32 v46, 16, v40
    s_and_b32 s44, s41, 0xffff0000
    v_mov_b32 v40, s44
    v_ashrrev_i32 v41, 31, v40
    v_not_b32 v41, v41
    v_or_b32 v41, 0x80000000, v41
    v_xor_b32 v40, v40, v41
    v_and_b32 v40, 0xffff0000, v40
    v_mul_f32 v40, 0xbfb8aa3b, v40
    v_exp_f32 v40, v40
    s_nop 0
    v_add_f32 v40, 1.0, v40
    v_rcp_f32 v40, v40
    s_nop 0
    v_cvt_pk_bf16_f32 v40, v40, v40
    v_lshlrev_b32 v47, 16, v40
    s_cmp_lg_u32 s2, 0
    s_cbranch_scc1 K2_NOSEL
    s_cmp_lg_u32 s22, 0
    s_cbranch_scc1 K2_NOSEL
    v_mov_b32 v44, s42
    v_mov_b32 v45, s43
    v_mov_b32 v40, 7602176
    v_cmp_eq_u32 vcc, 0, v1
    s_and_saveexec_b64 s[62:63], vcc
    buffer_store_dwordx4 v[44:47], v40, s[36:39], 0 offen
    s_mov_b64 exec, s[62:63]
K2_NOSEL:
    s_cmp_ge_u32 s22, 4
    s_cbranch_scc1 K2_MOE_W2
    s_and_b32 s44, s22, 1
    s_lshr_b32 s45, s22, 1
    v_mov_b32 v48, 0
    v_mov_b32 v49, 0
    v_mov_b32 v50, 0
    v_mov_b32 v51, 0
    v_mov_b32 v52, 0
    v_mov_b32 v53, 0
    v_mov_b32 v54, 0
    v_mov_b32 v55, 0
    v_mov_b32 v56, 0
    v_mov_b32 v57, 0
    v_mov_b32 v58, 0
    v_mov_b32 v59, 0
    v_mov_b32 v60, 0
    v_mov_b32 v61, 0
    v_mov_b32 v62, 0
    v_mov_b32 v63, 0
    v_mov_b32 v64, 0
    v_mov_b32 v65, 0
    v_mov_b32 v66, 0
    v_mov_b32 v67, 0
    v_mov_b32 v68, 0
    v_mov_b32 v69, 0
    v_mov_b32 v70, 0
    v_mov_b32 v71, 0
    v_mov_b32 v72, 0
    v_mov_b32 v73, 0
    v_mov_b32 v74, 0
    v_mov_b32 v75, 0
    v_mov_b32 v76, 0
    v_mov_b32 v77, 0
    v_mov_b32 v78, 0
    v_mov_b32 v79, 0
    v_mov_b32 v80, 0
    v_mov_b32 v81, 0
    v_mov_b32 v82, 0
    v_mov_b32 v83, 0
    v_mov_b32 v84, 0
    v_mov_b32 v85, 0
    v_mov_b32 v86, 0
    v_mov_b32 v87, 0
    v_mov_b32 v88, 0
    v_mov_b32 v89, 0
    v_mov_b32 v90, 0
    v_mov_b32 v91, 0
    v_mov_b32 v92, 0
    v_mov_b32 v93, 0
    v_mov_b32 v94, 0
    v_mov_b32 v95, 0
    v_mov_b32 v96, 0
    v_mov_b32 v97, 0
    v_mov_b32 v98, 0
    v_mov_b32 v99, 0
    v_mov_b32 v100, 0
    v_mov_b32 v101, 0
    v_mov_b32 v102, 0
    v_mov_b32 v103, 0
    v_mov_b32 v104, 0
    v_mov_b32 v105, 0
    v_mov_b32 v106, 0
    v_mov_b32 v107, 0
    v_mov_b32 v108, 0
    v_mov_b32 v109, 0
    v_mov_b32 v110, 0
    v_mov_b32 v111, 0
    v_and_b32 v2, 31, v1
    v_lshrrev_b32 v3, 5, v1
    v_mov_b32 v4, s42
    v_mov_b32 v5, s43
    v_cmp_eq_u32 vcc, 1, v2
    s_nop 1
    v_cndmask_b32 v4, v4, v5, vcc
    v_lshlrev_b32 v4, 10, v4
    v_lshl_add_u32 v4, v3, 4, v4
    s_lshl_b32 s46, s45, 9
    v_add_u32 v4, s46, v4
    v_cmp_gt_u32 vcc, 2, v2
    s_and_saveexec_b64 s[62:63], vcc
    buffer_load_dwordx4 v[48:51], v4, s[36:39], 0 offen offset:0
    buffer_load_dwordx4 v[52:55], v4, s[36:39], 0 offen offset:32
    buffer_load_dwordx4 v[56:59], v4, s[36:39], 0 offen offset:64
    buffer_load_dwordx4 v[60:63], v4, s[36:39], 0 offen offset:96
    buffer_load_dwordx4 v[64:67], v4, s[36:39], 0 offen offset:128
    buffer_load_dwordx4 v[68:71], v4, s[36:39], 0 offen offset:160
    buffer_load_dwordx4 v[72:75], v4, s[36:39], 0 offen offset:192
    buffer_load_dwordx4 v[76:79], v4, s[36:39], 0 offen offset:224
    buffer_load_dwordx4 v[80:83], v4, s[36:39], 0 offen offset:256
    buffer_load_dwordx4 v[84:87], v4, s[36:39], 0 offen offset:288
    buffer_load_dwordx4 v[88:91], v4, s[36:39], 0 offen offset:320
    buffer_load_dwordx4 v[92:95], v4, s[36:39], 0 offen offset:352
    buffer_load_dwordx4 v[96:99], v4, s[36:39], 0 offen offset:384
    buffer_load_dwordx4 v[100:103], v4, s[36:39], 0 offen offset:416
    buffer_load_dwordx4 v[104:107], v4, s[36:39], 0 offen offset:448
    buffer_load_dwordx4 v[108:111], v4, s[36:39], 0 offen offset:480
    s_mov_b64 exec, s[62:63]
    v_lshlrev_b32 v6, 9, v3
    v_bfe_u32 v7, v1, 2, 2
    v_lshl_add_u32 v6, v7, 6, v6
    v_bfe_u32 v7, v1, 4, 1
    v_lshl_add_u32 v6, v7, 5, v6
    v_and_b32 v7, 3, v1
    v_lshl_add_u32 v6, v7, 3, v6
    s_lshl_b32 s46, s44, 15
    s_lshl_b32 s47, s45, 14
    s_add_u32 s46, s46, s47
    v_add_u32 v6, s46, v6
    v_mov_b32 v8, 0
    v_mov_b32 v9, 0
    v_mov_b32 v10, 0
    v_mov_b32 v11, 0
    v_mov_b32 v12, 0
    v_mov_b32 v13, 0
    v_mov_b32 v14, 0
    v_mov_b32 v15, 0
    v_mov_b32 v16, 0
    v_mov_b32 v17, 0
    v_mov_b32 v18, 0
    v_mov_b32 v19, 0
    v_mov_b32 v20, 0
    v_mov_b32 v21, 0
    v_mov_b32 v22, 0
    v_mov_b32 v23, 0
    s_waitcnt vmcnt(0)
    s_barrier
    ds_read_b64_tr_b16 v[24:25], v6 offset:0
    ds_read_b64_tr_b16 v[26:27], v6 offset:256
    ds_read_b64_tr_b16 v[28:29], v6 offset:1024
    ds_read_b64_tr_b16 v[30:31], v6 offset:1280
    ds_read_b64_tr_b16 v[32:33], v6 offset:2048
    ds_read_b64_tr_b16 v[34:35], v6 offset:2304
    ds_read_b64_tr_b16 v[36:37], v6 offset:3072
    ds_read_b64_tr_b16 v[38:39], v6 offset:3328
    s_waitcnt lgkmcnt(0)
    v_mfma_f32_32x32x16_bf16 v[8:23], v[24:27], v[48:51], v[8:23]
    v_mfma_f32_32x32x16_bf16 v[8:23], v[28:31], v[52:55], v[8:23]
    v_mfma_f32_32x32x16_bf16 v[8:23], v[32:35], v[56:59], v[8:23]
    v_mfma_f32_32x32x16_bf16 v[8:23], v[36:39], v[60:63], v[8:23]
    ds_read_b64_tr_b16 v[24:25], v6 offset:4096
    ds_read_b64_tr_b16 v[26:27], v6 offset:4352
    ds_read_b64_tr_b16 v[28:29], v6 offset:5120
    ds_read_b64_tr_b16 v[30:31], v6 offset:5376
    ds_read_b64_tr_b16 v[32:33], v6 offset:6144
    ds_read_b64_tr_b16 v[34:35], v6 offset:6400
    ds_read_b64_tr_b16 v[36:37], v6 offset:7168
    ds_read_b64_tr_b16 v[38:39], v6 offset:7424
    s_waitcnt lgkmcnt(0)
    v_mfma_f32_32x32x16_bf16 v[8:23], v[24:27], v[64:67], v[8:23]
    v_mfma_f32_32x32x16_bf16 v[8:23], v[28:31], v[68:71], v[8:23]
    v_mfma_f32_32x32x16_bf16 v[8:23], v[32:35], v[72:75], v[8:23]
    v_mfma_f32_32x32x16_bf16 v[8:23], v[36:39], v[76:79], v[8:23]
    ds_read_b64_tr_b16 v[24:25], v6 offset:8192
    ds_read_b64_tr_b16 v[26:27], v6 offset:8448
    ds_read_b64_tr_b16 v[28:29], v6 offset:9216
    ds_read_b64_tr_b16 v[30:31], v6 offset:9472
    ds_read_b64_tr_b16 v[32:33], v6 offset:10240
    ds_read_b64_tr_b16 v[34:35], v6 offset:10496
    ds_read_b64_tr_b16 v[36:37], v6 offset:11264
    ds_read_b64_tr_b16 v[38:39], v6 offset:11520
    s_waitcnt lgkmcnt(0)
    v_mfma_f32_32x32x16_bf16 v[8:23], v[24:27], v[80:83], v[8:23]
    v_mfma_f32_32x32x16_bf16 v[8:23], v[28:31], v[84:87], v[8:23]
    v_mfma_f32_32x32x16_bf16 v[8:23], v[32:35], v[88:91], v[8:23]
    v_mfma_f32_32x32x16_bf16 v[8:23], v[36:39], v[92:95], v[8:23]
    ds_read_b64_tr_b16 v[24:25], v6 offset:12288
    ds_read_b64_tr_b16 v[26:27], v6 offset:12544
    ds_read_b64_tr_b16 v[28:29], v6 offset:13312
    ds_read_b64_tr_b16 v[30:31], v6 offset:13568
    ds_read_b64_tr_b16 v[32:33], v6 offset:14336
    ds_read_b64_tr_b16 v[34:35], v6 offset:14592
    ds_read_b64_tr_b16 v[36:37], v6 offset:15360
    ds_read_b64_tr_b16 v[38:39], v6 offset:15616
    s_waitcnt lgkmcnt(0)
    v_mfma_f32_32x32x16_bf16 v[8:23], v[24:27], v[96:99], v[8:23]
    v_mfma_f32_32x32x16_bf16 v[8:23], v[28:31], v[100:103], v[8:23]
    v_mfma_f32_32x32x16_bf16 v[8:23], v[32:35], v[104:107], v[8:23]
    v_mfma_f32_32x32x16_bf16 v[8:23], v[36:39], v[108:111], v[8:23]
    s_nop 15
    s_nop 3
    s_lshl_b32 s46, s22, 8
    v_lshlrev_b32 v7, 5, v3
    v_lshl_add_u32 v7, v2, 2, v7
    v_add_u32 v7, s46, v7
    v_add_u32 v7, 98304, v7
    v_cmp_gt_u32 vcc, 2, v2
    s_and_saveexec_b64 s[62:63], vcc
    ds_write_b32 v7, v8 offset:0
    ds_write_b32 v7, v9 offset:8
    ds_write_b32 v7, v10 offset:16
    ds_write_b32 v7, v11 offset:24
    ds_write_b32 v7, v12 offset:64
    ds_write_b32 v7, v13 offset:72
    ds_write_b32 v7, v14 offset:80
    ds_write_b32 v7, v15 offset:88
    ds_write_b32 v7, v16 offset:128
    ds_write_b32 v7, v17 offset:136
    ds_write_b32 v7, v18 offset:144
    ds_write_b32 v7, v19 offset:152
    ds_write_b32 v7, v20 offset:192
    ds_write_b32 v7, v21 offset:200
    ds_write_b32 v7, v22 offset:208
    ds_write_b32 v7, v23 offset:216
    s_mov_b64 exec, s[62:63]
    s_waitcnt lgkmcnt(0)
    s_barrier
    s_branch K2_MOE_H
K2_MOE_W2:
    s_waitcnt vmcnt(0)
    s_barrier
    s_barrier
K2_MOE_H:
    v_and_b32 v2, 31, v1
    v_lshrrev_b32 v3, 5, v1
    v_lshlrev_b32 v7, 3, v2
    v_lshl_add_u32 v7, v3, 2, v7
    v_add_u32 v7, 98304, v7
    ds_read_b32 v8, v7
    ds_read_b32 v9, v7 offset:512
    ds_read_b32 v10, v7 offset:256
    ds_read_b32 v11, v7 offset:768
    s_waitcnt lgkmcnt(0)
    v_add_f32 v8, v8, v9
    v_add_f32 v10, v10, v11
    v_cvt_pk_bf16_f32 v8, v8, v10
    v_lshlrev_b32 v9, 16, v8
    v_and_b32 v10, 0xffff0000, v8
    v_mul_f32 v11, 0xbfb8aa3b, v9
    v_exp_f32 v11, v11
    s_nop 0
    v_add_f32 v11, 1.0, v11
    v_rcp_f32 v11, v11
    s_nop 0
    v_mul_f32 v9, v9, v11
    v_cvt_pk_bf16_f32 v9, v9, v9
    v_lshlrev_b32 v9, 16, v9
    v_mul_f32 v9, v9, v10
    v_cvt_pk_bf16_f32 v9, v9, v9
    v_lshlrev_b32 v7, 1, v2
    v_lshl_add_u32 v7, v3, 6, v7
    v_add_u32 v7, 99328, v7
    s_cmp_lg_u32 s22, 0
    s_cbranch_scc1 K2_MOE_NOH
    ds_write_b16 v7, v9
    s_waitcnt lgkmcnt(0)
K2_MOE_NOH:
    s_barrier
    v_mov_b32 v40, 0
    v_mov_b32 v41, 0
    v_mov_b32 v42, 0
    v_mov_b32 v43, 0
    v_mov_b32 v44, 0
    v_mov_b32 v45, 0
    v_mov_b32 v46, 0
    v_mov_b32 v47, 0
    v_lshlrev_b32 v7, 6, v2
    v_lshl_add_u32 v7, v3, 4, v7
    v_add_u32 v7, 99328, v7
    v_cmp_gt_u32 vcc, 2, v2
    s_and_saveexec_b64 s[62:63], vcc
    ds_read_b128 v[40:43], v7
    ds_read_b128 v[44:47], v7 offset:32
    s_mov_b64 exec, s[62:63]
    v_lshlrev_b32 v6, 13, v3
    v_bfe_u32 v8, v1, 2, 2
    v_lshl_add_u32 v6, v8, 10, v6
    v_bfe_u32 v8, v1, 4, 1
    v_lshl_add_u32 v6, v8, 5, v6
    v_and_b32 v8, 3, v1
    v_lshl_add_u32 v6, v8, 3, v6
    s_lshl_b32 s46, s22, 7
    v_add_u32 v6, s46, v6
    v_add_u32 v6, 65536, v6
    s_lshl_b32 s47, s22, 8
    s_add_u32 s46, s47, 7340032
    v_lshlrev_b32 v5, 11, v2
    v_lshl_add_u32 v5, v3, 4, v5
    v_mov_b32 v8, 0
    v_mov_b32 v9, 0
    v_mov_b32 v10, 0
    v_mov_b32 v11, 0
    v_mov_b32 v12, 0
    v_mov_b32 v13, 0
    v_mov_b32 v14, 0
    v_mov_b32 v15, 0
    v_mov_b32 v16, 0
    v_mov_b32 v17, 0
    v_mov_b32 v18, 0
    v_mov_b32 v19, 0
    v_mov_b32 v20, 0
    v_mov_b32 v21, 0
    v_mov_b32 v22, 0
    v_mov_b32 v23, 0
    ds_read_b64_tr_b16 v[24:25], v6 offset:0
    ds_read_b64_tr_b16 v[26:27], v6 offset:4096
    ds_read_b64_tr_b16 v[28:29], v6 offset:16384
    ds_read_b64_tr_b16 v[30:31], v6 offset:20480
    s_waitcnt lgkmcnt(0)
    v_mfma_f32_32x32x16_bf16 v[8:23], v[24:27], v[40:43], v[8:23]
    v_mfma_f32_32x32x16_bf16 v[8:23], v[28:31], v[44:47], v[8:23]
    s_nop 15
    s_nop 3
    v_cmp_gt_u32 vcc, 2, v2
    s_and_saveexec_b64 s[62:63], vcc
    v_add_u32 v4, s47, v5
    v_add_u32 v4, 100352, v4
    ds_write_b128 v4, v[8:11] offset:0
    ds_write_b128 v4, v[12:15] offset:32
    ds_write_b128 v4, v[16:19] offset:64
    ds_write_b128 v4, v[20:23] offset:96
    s_mov_b64 exec, s[62:63]
    v_mov_b32 v8, 0
    v_mov_b32 v9, 0
    v_mov_b32 v10, 0
    v_mov_b32 v11, 0
    v_mov_b32 v12, 0
    v_mov_b32 v13, 0
    v_mov_b32 v14, 0
    v_mov_b32 v15, 0
    v_mov_b32 v16, 0
    v_mov_b32 v17, 0
    v_mov_b32 v18, 0
    v_mov_b32 v19, 0
    v_mov_b32 v20, 0
    v_mov_b32 v21, 0
    v_mov_b32 v22, 0
    v_mov_b32 v23, 0
    ds_read_b64_tr_b16 v[24:25], v6 offset:64
    ds_read_b64_tr_b16 v[26:27], v6 offset:4160
    ds_read_b64_tr_b16 v[28:29], v6 offset:16448
    ds_read_b64_tr_b16 v[30:31], v6 offset:20544
    s_waitcnt lgkmcnt(0)
    v_mfma_f32_32x32x16_bf16 v[8:23], v[24:27], v[40:43], v[8:23]
    v_mfma_f32_32x32x16_bf16 v[8:23], v[28:31], v[44:47], v[8:23]
    s_nop 15
    s_nop 3
    v_cmp_gt_u32 vcc, 2, v2
    s_and_saveexec_b64 s[62:63], vcc
    v_add_u32 v4, s47, v5
    v_add_u32 v4, 100352, v4
    ds_write_b128 v4, v[8:11] offset:128
    ds_write_b128 v4, v[12:15] offset:160
    ds_write_b128 v4, v[16:19] offset:192
    ds_write_b128 v4, v[20:23] offset:224
    s_mov_b64 exec, s[62:63]
    s_waitcnt lgkmcnt(0)
    s_barrier
    v_lshlrev_b32 v4, 2, v0
    v_add_u32 v5, 100352, v4
    ds_read_b32 v6, v5
    ds_read_b32 v7, v5 offset:2048
    s_waitcnt lgkmcnt(0)
    v_add_u32 v4, 7340032, v4
    buffer_atomic_add_f32 v6, v4, s[36:39], 0 offen
    buffer_atomic_add_f32 v7, v4, s[36:39], 0 offen offset:2048
K2_END:
    s_endpgm
.globl out_kernel
.p2align 8
.type out_kernel,@function
out_kernel:
    s_cmp_ge_u32 s2, 256
    s_cbranch_scc1 K3_END
    s_load_dwordx2 s[4:5], s[0:1], 0
    s_load_dwordx2 s[6:7], s[0:1], 32
    s_load_dwordx2 s[8:9], s[0:1], 80
    s_load_dwordx2 s[14:15], s[0:1], 96
    s_and_b32 s20, s2, 31
    s_lshr_b32 s21, s2, 5
    v_and_b32 v1, 63, v0
    v_lshrrev_b32 v2, 6, v0
    s_nop 0
    v_readfirstlane_b32 s22, v2
    s_waitcnt lgkmcnt(0)
    s_add_u32 s16, s14, 7602176
    s_addc_u32 s17, s15, 0
    s_load_dwordx4 s[48:51], s[16:17], 0
    s_mov_b32 s24, s4
    s_and_b32 s25, s5, 0xffff
    s_mov_b32 s26, 0x200000
    s_mov_b32 s27, 0x00020000
    s_mov_b32 s28, s6
    s_and_b32 s29, s7, 0xffff
    s_mov_b32 s30, 0x80000
    s_mov_b32 s31, 0x00020000
    s_mov_b32 s32, s8
    s_and_b32 s33, s9, 0xffff
    s_mov_b32 s34, 0x200000
    s_mov_b32 s35, 0x00020000
    s_mov_b32 s36, s14
    s_and_b32 s37, s15, 0xffff
    s_mov_b32 s38, 0x800000
    s_mov_b32 s39, 0x00020000
    s_and_b32 s23, s22, 1
    s_lshr_b32 s19, s22, 1
    v_lshrrev_b32 v2, 3, v1
    v_lshlrev_b32 v2, 10, v2
    v_and_b32 v3, 7, v1
    v_lshlrev_b32 v3, 4, v3
    v_add_u32 v2, v2, v3
    s_lshl_b32 s60, s22, 17
    s_lshl_b32 s61, s21, 7
    s_add_u32 s60, s60, s61
    s_lshl_b32 s61, s22, 14
    s_add_u32 s61, s61, 66560
    s_mov_b32 m0, s61
    s_nop 0
    buffer_load_dwordx4 v2, s[28:31], s60 offen lds
    s_add_u32 s60, s60, 8192
    s_add_u32 s61, s61, 1024
    s_mov_b32 m0, s61
    s_nop 0
    buffer_load_dwordx4 v2, s[28:31], s60 offen lds
    s_add_u32 s60, s60, 8192
    s_add_u32 s61, s61, 1024
    s_mov_b32 m0, s61
    s_nop 0
    buffer_load_dwordx4 v2, s[28:31], s60 offen lds
    s_add_u32 s60, s60, 8192
    s_add_u32 s61, s61, 1024
    s_mov_b32 m0, s61
    s_nop 0
    buffer_load_dwordx4 v2, s[28:31], s60 offen lds
    s_add_u32 s60, s60, 8192
    s_add_u32 s61, s61, 1024
    s_mov_b32 m0, s61
    s_nop 0
    buffer_load_dwordx4 v2, s[28:31], s60 offen lds
    s_add_u32 s60, s60, 8192
    s_add_u32 s61, s61, 1024
    s_mov_b32 m0, s61
    s_nop 0
    buffer_load_dwordx4 v2, s[28:31], s60 offen lds
    s_add_u32 s60, s60, 8192
    s_add_u32 s61, s61, 1024
    s_mov_b32 m0, s61
    s_nop 0
    buffer_load_dwordx4 v2, s[28:31], s60 offen lds
    s_add_u32 s60, s60, 8192
    s_add_u32 s61, s61, 1024
    s_mov_b32 m0, s61
    s_nop 0
    buffer_load_dwordx4 v2, s[28:31], s60 offen lds
    s_add_u32 s60, s60, 8192
    s_add_u32 s61, s61, 1024
    s_mov_b32 m0, s61
    s_nop 0
    buffer_load_dwordx4 v2, s[28:31], s60 offen lds
    s_add_u32 s60, s60, 8192
    s_add_u32 s61, s61, 1024
    s_mov_b32 m0, s61
    s_nop 0
    buffer_load_dwordx4 v2, s[28:31], s60 offen lds
    s_add_u32 s60, s60, 8192
    s_add_u32 s61, s61, 1024
    s_mov_b32 m0, s61
    s_nop 0
    buffer_load_dwordx4 v2, s[28:31], s60 offen lds
    s_add_u32 s60, s60, 8192
    s_add_u32 s61, s61, 1024
    s_mov_b32 m0, s61
    s_nop 0
    buffer_load_dwordx4 v2, s[28:31], s60 offen lds
    s_add_u32 s60, s60, 8192
    s_add_u32 s61, s61, 1024
    s_mov_b32 m0, s61
    s_nop 0
    buffer_load_dwordx4 v2, s[28:31], s60 offen lds
    s_add_u32 s60, s60, 8192
    s_add_u32 s61, s61, 1024
    s_mov_b32 m0, s61
    s_nop 0
    buffer_load_dwordx4 v2, s[28:31], s60 offen lds
    s_add_u32 s60, s60, 8192
    s_add_u32 s61, s61, 1024
    s_mov_b32 m0, s61
    s_nop 0
    buffer_load_dwordx4 v2, s[28:31], s60 offen lds
    s_add_u32 s60, s60, 8192
    s_add_u32 s61, s61, 1024
    s_mov_b32 m0, s61
    s_nop 0
    buffer_load_dwordx4 v2, s[28:31], s60 offen lds
    s_add_u32 s60, s60, 8192
    s_add_u32 s61, s61, 1024
    v_and_b32 v8, 31, v1
    s_lshl_b32 s62, s23, 5
    s_lshl_b32 s63, s20, 6
    s_add_u32 s62, s62, s63
    v_add_u32 v8, s62, v8
    v_lshrrev_b32 v10, 5, v1
    v_lshlrev_b32 v9, 10, v8
    v_lshl_add_u32 v9, v10, 4, v9
    v_add_u32 v9, 5242880, v9
    buffer_load_dwordx4 v[64:67], v9, s[36:39], 0 offen offset:0
    buffer_load_dwordx4 v[68:71], v9, s[36:39], 0 offen offset:32
    buffer_load_dwordx4 v[72:75], v9, s[36:39], 0 offen offset:64
    buffer_load_dwordx4 v[76:79], v9, s[36:39], 0 offen offset:96
    buffer_load_dwordx4 v[80:83], v9, s[36:39], 0 offen offset:128
    buffer_load_dwordx4 v[84:87], v9, s[36:39], 0 offen offset:160
    buffer_load_dwordx4 v[88:91], v9, s[36:39], 0 offen offset:192
    buffer_load_dwordx4 v[92:95], v9, s[36:39], 0 offen offset:224
    buffer_load_dwordx4 v[96:99], v9, s[36:39], 0 offen offset:256
    buffer_load_dwordx4 v[100:103], v9, s[36:39], 0 offen offset:288
    buffer_load_dwordx4 v[104:107], v9, s[36:39], 0 offen offset:320
    buffer_load_dwordx4 v[108:111], v9, s[36:39], 0 offen offset:352
    buffer_load_dwordx4 v[112:115], v9, s[36:39], 0 offen offset:384
    buffer_load_dwordx4 v[116:119], v9, s[36:39], 0 offen offset:416
    buffer_load_dwordx4 v[120:123], v9, s[36:39], 0 offen offset:448
    buffer_load_dwordx4 v[124:127], v9, s[36:39], 0 offen offset:480
    buffer_load_dwordx4 v[128:131], v9, s[36:39], 0 offen offset:512
    buffer_load_dwordx4 v[132:135], v9, s[36:39], 0 offen offset:544
    buffer_load_dwordx4 v[136:139], v9, s[36:39], 0 offen offset:576
    buffer_load_dwordx4 v[140:143], v9, s[36:39], 0 offen offset:608
    buffer_load_dwordx4 v[144:147], v9, s[36:39], 0 offen offset:640
    buffer_load_dwordx4 v[148:151], v9, s[36:39], 0 offen offset:672
    buffer_load_dwordx4 v[152:155], v9, s[36:39], 0 offen offset:704
    buffer_load_dwordx4 v[156:159], v9, s[36:39], 0 offen offset:736
    buffer_load_dwordx4 v[160:163], v9, s[36:39], 0 offen offset:768
    buffer_load_dwordx4 v[164:167], v9, s[36:39], 0 offen offset:800
    buffer_load_dwordx4 v[168:171], v9, s[36:39], 0 offen offset:832
    buffer_load_dwordx4 v[172:175], v9, s[36:39], 0 offen offset:864
    buffer_load_dwordx4 v[176:179], v9, s[36:39], 0 offen offset:896
    buffer_load_dwordx4 v[180:183], v9, s[36:39], 0 offen offset:928
    buffer_load_dwordx4 v[184:187], v9, s[36:39], 0 offen offset:960
    buffer_load_dwordx4 v[188:191], v9, s[36:39], 0 offen offset:992
    s_lshl_b32 s62, s21, 7
    s_lshl_b32 s63, s19, 6
    s_add_u32 s62, s62, s63
    v_lshlrev_b32 v12, 10, v8
    v_lshl_add_u32 v12, v10, 3, v12
    v_add_u32 v12, s62, v12
    buffer_load_dwordx2 v[192:193], v12, s[24:27], 0 offen offset:0
    buffer_load_dwordx2 v[200:201], v12, s[36:39], 0 offen offset:0
    buffer_load_dwordx2 v[194:195], v12, s[24:27], 0 offen offset:16
    buffer_load_dwordx2 v[202:203], v12, s[36:39], 0 offen offset:16
    buffer_load_dwordx2 v[196:197], v12, s[24:27], 0 offen offset:32
    buffer_load_dwordx2 v[204:205], v12, s[36:39], 0 offen offset:32
    buffer_load_dwordx2 v[198:199], v12, s[24:27], 0 offen offset:48
    buffer_load_dwordx2 v[206:207], v12, s[36:39], 0 offen offset:48
    s_lshl_b32 s62, s19, 6
    v_lshrrev_b32 v13, 5, v1
    v_lshlrev_b32 v11, 10, v13
    v_bfe_u32 v13, v1, 2, 2
    v_lshl_add_u32 v11, v13, 7, v11
    v_bfe_u32 v13, v1, 4, 1
    v_lshl_add_u32 v11, v13, 5, v11
    v_and_b32 v13, 3, v1
    v_lshl_add_u32 v11, v13, 3, v11
    v_add_u32 v11, s62, v11
    v_add_u32 v11, 66560, v11
    s_waitcnt vmcnt(0)
    s_barrier
    v_mov_b32 v16, 0
    v_mov_b32 v17, 0
    v_mov_b32 v18, 0
    v_mov_b32 v19, 0
    v_mov_b32 v20, 0
    v_mov_b32 v21, 0
    v_mov_b32 v22, 0
    v_mov_b32 v23, 0
    v_mov_b32 v24, 0
    v_mov_b32 v25, 0
    v_mov_b32 v26, 0
    v_mov_b32 v27, 0
    v_mov_b32 v28, 0
    v_mov_b32 v29, 0
    v_mov_b32 v30, 0
    v_mov_b32 v31, 0
    ds_read_b64_tr_b16 v[32:33], v11 offset:0
    ds_read_b64_tr_b16 v[34:35], v11 offset:512
    ds_read_b64_tr_b16 v[36:37], v11 offset:2048
    ds_read_b64_tr_b16 v[38:39], v11 offset:2560
    ds_read_b64_tr_b16 v[40:41], v11 offset:4096
    ds_read_b64_tr_b16 v[42:43], v11 offset:4608
    ds_read_b64_tr_b16 v[44:45], v11 offset:6144
    ds_read_b64_tr_b16 v[46:47], v11 offset:6656
    s_waitcnt lgkmcnt(0)
    v_mfma_f32_32x32x16_bf16 v[16:31], v[32:35], v[64:67], v[16:31]
    v_mfma_f32_32x32x16_bf16 v[16:31], v[36:39], v[68:71], v[16:31]
    v_mfma_f32_32x32x16_bf16 v[16:31], v[40:43], v[72:75], v[16:31]
    v_mfma_f32_32x32x16_bf16 v[16:31], v[44:47], v[76:79], v[16:31]
    ds_read_b64_tr_b16 v[32:33], v11 offset:8192
    ds_read_b64_tr_b16 v[34:35], v11 offset:8704
    ds_read_b64_tr_b16 v[36:37], v11 offset:10240
    ds_read_b64_tr_b16 v[38:39], v11 offset:10752
    ds_read_b64_tr_b16 v[40:41], v11 offset:12288
    ds_read_b64_tr_b16 v[42:43], v11 offset:12800
    ds_read_b64_tr_b16 v[44:45], v11 offset:14336
    ds_read_b64_tr_b16 v[46:47], v11 offset:14848
    s_waitcnt lgkmcnt(0)
    v_mfma_f32_32x32x16_bf16 v[16:31], v[32:35], v[80:83], v[16:31]
    v_mfma_f32_32x32x16_bf16 v[16:31], v[36:39], v[84:87], v[16:31]
    v_mfma_f32_32x32x16_bf16 v[16:31], v[40:43], v[88:91], v[16:31]
    v_mfma_f32_32x32x16_bf16 v[16:31], v[44:47], v[92:95], v[16:31]
    ds_read_b64_tr_b16 v[32:33], v11 offset:16384
    ds_read_b64_tr_b16 v[34:35], v11 offset:16896
    ds_read_b64_tr_b16 v[36:37], v11 offset:18432
    ds_read_b64_tr_b16 v[38:39], v11 offset:18944
    ds_read_b64_tr_b16 v[40:41], v11 offset:20480
    ds_read_b64_tr_b16 v[42:43], v11 offset:20992
    ds_read_b64_tr_b16 v[44:45], v11 offset:22528
    ds_read_b64_tr_b16 v[46:47], v11 offset:23040
    s_waitcnt lgkmcnt(0)
    v_mfma_f32_32x32x16_bf16 v[16:31], v[32:35], v[96:99], v[16:31]
    v_mfma_f32_32x32x16_bf16 v[16:31], v[36:39], v[100:103], v[16:31]
    v_mfma_f32_32x32x16_bf16 v[16:31], v[40:43], v[104:107], v[16:31]
    v_mfma_f32_32x32x16_bf16 v[16:31], v[44:47], v[108:111], v[16:31]
    ds_read_b64_tr_b16 v[32:33], v11 offset:24576
    ds_read_b64_tr_b16 v[34:35], v11 offset:25088
    ds_read_b64_tr_b16 v[36:37], v11 offset:26624
    ds_read_b64_tr_b16 v[38:39], v11 offset:27136
    ds_read_b64_tr_b16 v[40:41], v11 offset:28672
    ds_read_b64_tr_b16 v[42:43], v11 offset:29184
    ds_read_b64_tr_b16 v[44:45], v11 offset:30720
    ds_read_b64_tr_b16 v[46:47], v11 offset:31232
    s_waitcnt lgkmcnt(0)
    v_mfma_f32_32x32x16_bf16 v[16:31], v[32:35], v[112:115], v[16:31]
    v_mfma_f32_32x32x16_bf16 v[16:31], v[36:39], v[116:119], v[16:31]
    v_mfma_f32_32x32x16_bf16 v[16:31], v[40:43], v[120:123], v[16:31]
    v_mfma_f32_32x32x16_bf16 v[16:31], v[44:47], v[124:127], v[16:31]
    ds_read_b64_tr_b16 v[32:33], v11 offset:32768
    ds_read_b64_tr_b16 v[34:35], v11 offset:33280
    ds_read_b64_tr_b16 v[36:37], v11 offset:34816
    ds_read_b64_tr_b16 v[38:39], v11 offset:35328
    ds_read_b64_tr_b16 v[40:41], v11 offset:36864
    ds_read_b64_tr_b16 v[42:43], v11 offset:37376
    ds_read_b64_tr_b16 v[44:45], v11 offset:38912
    ds_read_b64_tr_b16 v[46:47], v11 offset:39424
    s_waitcnt lgkmcnt(0)
    v_mfma_f32_32x32x16_bf16 v[16:31], v[32:35], v[128:131], v[16:31]
    v_mfma_f32_32x32x16_bf16 v[16:31], v[36:39], v[132:135], v[16:31]
    v_mfma_f32_32x32x16_bf16 v[16:31], v[40:43], v[136:139], v[16:31]
    v_mfma_f32_32x32x16_bf16 v[16:31], v[44:47], v[140:143], v[16:31]
    ds_read_b64_tr_b16 v[32:33], v11 offset:40960
    ds_read_b64_tr_b16 v[34:35], v11 offset:41472
    ds_read_b64_tr_b16 v[36:37], v11 offset:43008
    ds_read_b64_tr_b16 v[38:39], v11 offset:43520
    ds_read_b64_tr_b16 v[40:41], v11 offset:45056
    ds_read_b64_tr_b16 v[42:43], v11 offset:45568
    ds_read_b64_tr_b16 v[44:45], v11 offset:47104
    ds_read_b64_tr_b16 v[46:47], v11 offset:47616
    s_waitcnt lgkmcnt(0)
    v_mfma_f32_32x32x16_bf16 v[16:31], v[32:35], v[144:147], v[16:31]
    v_mfma_f32_32x32x16_bf16 v[16:31], v[36:39], v[148:151], v[16:31]
    v_mfma_f32_32x32x16_bf16 v[16:31], v[40:43], v[152:155], v[16:31]
    v_mfma_f32_32x32x16_bf16 v[16:31], v[44:47], v[156:159], v[16:31]
    ds_read_b64_tr_b16 v[32:33], v11 offset:49152
    ds_read_b64_tr_b16 v[34:35], v11 offset:49664
    ds_read_b64_tr_b16 v[36:37], v11 offset:51200
    ds_read_b64_tr_b16 v[38:39], v11 offset:51712
    ds_read_b64_tr_b16 v[40:41], v11 offset:53248
    ds_read_b64_tr_b16 v[42:43], v11 offset:53760
    ds_read_b64_tr_b16 v[44:45], v11 offset:55296
    ds_read_b64_tr_b16 v[46:47], v11 offset:55808
    s_waitcnt lgkmcnt(0)
    v_mfma_f32_32x32x16_bf16 v[16:31], v[32:35], v[160:163], v[16:31]
    v_mfma_f32_32x32x16_bf16 v[16:31], v[36:39], v[164:167], v[16:31]
    v_mfma_f32_32x32x16_bf16 v[16:31], v[40:43], v[168:171], v[16:31]
    v_mfma_f32_32x32x16_bf16 v[16:31], v[44:47], v[172:175], v[16:31]
    ds_read_b64_tr_b16 v[32:33], v11 offset:57344
    ds_read_b64_tr_b16 v[34:35], v11 offset:57856
    ds_read_b64_tr_b16 v[36:37], v11 offset:59392
    ds_read_b64_tr_b16 v[38:39], v11 offset:59904
    ds_read_b64_tr_b16 v[40:41], v11 offset:61440
    ds_read_b64_tr_b16 v[42:43], v11 offset:61952
    ds_read_b64_tr_b16 v[44:45], v11 offset:63488
    ds_read_b64_tr_b16 v[46:47], v11 offset:64000
    s_waitcnt lgkmcnt(0)
    v_mfma_f32_32x32x16_bf16 v[16:31], v[32:35], v[176:179], v[16:31]
    v_mfma_f32_32x32x16_bf16 v[16:31], v[36:39], v[180:183], v[16:31]
    v_mfma_f32_32x32x16_bf16 v[16:31], v[40:43], v[184:187], v[16:31]
    v_mfma_f32_32x32x16_bf16 v[16:31], v[44:47], v[188:191], v[16:31]
    s_nop 15
    s_nop 3
    v_lshlrev_b32 v208, 16, v200
    v_and_b32 v209, 0xffff0000, v200
    v_lshlrev_b32 v210, 16, v201
    v_and_b32 v211, 0xffff0000, v201
    v_lshlrev_b32 v212, 16, v202
    v_and_b32 v213, 0xffff0000, v202
    v_lshlrev_b32 v214, 16, v203
    v_and_b32 v215, 0xffff0000, v203
    v_lshlrev_b32 v216, 16, v204
    v_and_b32 v217, 0xffff0000, v204
    v_lshlrev_b32 v218, 16, v205
    v_and_b32 v219, 0xffff0000, v205
    v_lshlrev_b32 v220, 16, v206
    v_and_b32 v221, 0xffff0000, v206
    v_lshlrev_b32 v222, 16, v207
    v_and_b32 v223, 0xffff0000, v207
    s_waitcnt lgkmcnt(0)
    v_cmp_eq_u32 vcc, s48, v8
    s_and_saveexec_b64 s[62:63], vcc
    s_cbranch_execz K3_NOMOE0
    s_lshl_b32 s60, s21, 8
    s_lshl_b32 s61, s19, 7
    s_add_u32 s60, s60, s61
    v_lshlrev_b32 v13, 4, v10
    v_add_u32 v13, s60, v13
    v_add_u32 v13, 7340032, v13
    buffer_load_dwordx4 v[32:35], v13, s[36:39], 0 offen offset:0
    buffer_load_dwordx4 v[36:39], v13, s[36:39], 0 offen offset:32
    buffer_load_dwordx4 v[40:43], v13, s[36:39], 0 offen offset:64
    buffer_load_dwordx4 v[44:47], v13, s[36:39], 0 offen offset:96
    s_waitcnt vmcnt(0)
    v_cvt_pk_bf16_f32 v32, v32, v32
    v_lshlrev_b32 v32, 16, v32
    v_mul_f32 v32, s50, v32
    v_cvt_pk_bf16_f32 v32, v32, v32
    v_lshlrev_b32 v32, 16, v32
    v_add_f32 v208, v208, v32
    v_cvt_pk_bf16_f32 v208, v208, v208
    v_lshlrev_b32 v208, 16, v208
    v_cvt_pk_bf16_f32 v33, v33, v33
    v_lshlrev_b32 v33, 16, v33
    v_mul_f32 v33, s50, v33
    v_cvt_pk_bf16_f32 v33, v33, v33
    v_lshlrev_b32 v33, 16, v33
    v_add_f32 v209, v209, v33
    v_cvt_pk_bf16_f32 v209, v209, v209
    v_lshlrev_b32 v209, 16, v209
    v_cvt_pk_bf16_f32 v34, v34, v34
    v_lshlrev_b32 v34, 16, v34
    v_mul_f32 v34, s50, v34
    v_cvt_pk_bf16_f32 v34, v34, v34
    v_lshlrev_b32 v34, 16, v34
    v_add_f32 v210, v210, v34
    v_cvt_pk_bf16_f32 v210, v210, v210
    v_lshlrev_b32 v210, 16, v210
    v_cvt_pk_bf16_f32 v35, v35, v35
    v_lshlrev_b32 v35, 16, v35
    v_mul_f32 v35, s50, v35
    v_cvt_pk_bf16_f32 v35, v35, v35
    v_lshlrev_b32 v35, 16, v35
    v_add_f32 v211, v211, v35
    v_cvt_pk_bf16_f32 v211, v211, v211
    v_lshlrev_b32 v211, 16, v211
    v_cvt_pk_bf16_f32 v36, v36, v36
    v_lshlrev_b32 v36, 16, v36
    v_mul_f32 v36, s50, v36
    v_cvt_pk_bf16_f32 v36, v36, v36
    v_lshlrev_b32 v36, 16, v36
    v_add_f32 v212, v212, v36
    v_cvt_pk_bf16_f32 v212, v212, v212
    v_lshlrev_b32 v212, 16, v212
    v_cvt_pk_bf16_f32 v37, v37, v37
    v_lshlrev_b32 v37, 16, v37
    v_mul_f32 v37, s50, v37
    v_cvt_pk_bf16_f32 v37, v37, v37
    v_lshlrev_b32 v37, 16, v37
    v_add_f32 v213, v213, v37
    v_cvt_pk_bf16_f32 v213, v213, v213
    v_lshlrev_b32 v213, 16, v213
    v_cvt_pk_bf16_f32 v38, v38, v38
    v_lshlrev_b32 v38, 16, v38
    v_mul_f32 v38, s50, v38
    v_cvt_pk_bf16_f32 v38, v38, v38
    v_lshlrev_b32 v38, 16, v38
    v_add_f32 v214, v214, v38
    v_cvt_pk_bf16_f32 v214, v214, v214
    v_lshlrev_b32 v214, 16, v214
    v_cvt_pk_bf16_f32 v39, v39, v39
    v_lshlrev_b32 v39, 16, v39
    v_mul_f32 v39, s50, v39
    v_cvt_pk_bf16_f32 v39, v39, v39
    v_lshlrev_b32 v39, 16, v39
    v_add_f32 v215, v215, v39
    v_cvt_pk_bf16_f32 v215, v215, v215
    v_lshlrev_b32 v215, 16, v215
    v_cvt_pk_bf16_f32 v40, v40, v40
    v_lshlrev_b32 v40, 16, v40
    v_mul_f32 v40, s50, v40
    v_cvt_pk_bf16_f32 v40, v40, v40
    v_lshlrev_b32 v40, 16, v40
    v_add_f32 v216, v216, v40
    v_cvt_pk_bf16_f32 v216, v216, v216
    v_lshlrev_b32 v216, 16, v216
    v_cvt_pk_bf16_f32 v41, v41, v41
    v_lshlrev_b32 v41, 16, v41
    v_mul_f32 v41, s50, v41
    v_cvt_pk_bf16_f32 v41, v41, v41
    v_lshlrev_b32 v41, 16, v41
    v_add_f32 v217, v217, v41
    v_cvt_pk_bf16_f32 v217, v217, v217
    v_lshlrev_b32 v217, 16, v217
    v_cvt_pk_bf16_f32 v42, v42, v42
    v_lshlrev_b32 v42, 16, v42
    v_mul_f32 v42, s50, v42
    v_cvt_pk_bf16_f32 v42, v42, v42
    v_lshlrev_b32 v42, 16, v42
    v_add_f32 v218, v218, v42
    v_cvt_pk_bf16_f32 v218, v218, v218
    v_lshlrev_b32 v218, 16, v218
    v_cvt_pk_bf16_f32 v43, v43, v43
    v_lshlrev_b32 v43, 16, v43
    v_mul_f32 v43, s50, v43
    v_cvt_pk_bf16_f32 v43, v43, v43
    v_lshlrev_b32 v43, 16, v43
    v_add_f32 v219, v219, v43
    v_cvt_pk_bf16_f32 v219, v219, v219
    v_lshlrev_b32 v219, 16, v219
    v_cvt_pk_bf16_f32 v44, v44, v44
    v_lshlrev_b32 v44, 16, v44
    v_mul_f32 v44, s50, v44
    v_cvt_pk_bf16_f32 v44, v44, v44
    v_lshlrev_b32 v44, 16, v44
    v_add_f32 v220, v220, v44
    v_cvt_pk_bf16_f32 v220, v220, v220
    v_lshlrev_b32 v220, 16, v220
    v_cvt_pk_bf16_f32 v45, v45, v45
    v_lshlrev_b32 v45, 16, v45
    v_mul_f32 v45, s50, v45
    v_cvt_pk_bf16_f32 v45, v45, v45
    v_lshlrev_b32 v45, 16, v45
    v_add_f32 v221, v221, v45
    v_cvt_pk_bf16_f32 v221, v221, v221
    v_lshlrev_b32 v221, 16, v221
    v_cvt_pk_bf16_f32 v46, v46, v46
    v_lshlrev_b32 v46, 16, v46
    v_mul_f32 v46, s50, v46
    v_cvt_pk_bf16_f32 v46, v46, v46
    v_lshlrev_b32 v46, 16, v46
    v_add_f32 v222, v222, v46
    v_cvt_pk_bf16_f32 v222, v222, v222
    v_lshlrev_b32 v222, 16, v222
    v_cvt_pk_bf16_f32 v47, v47, v47
    v_lshlrev_b32 v47, 16, v47
    v_mul_f32 v47, s50, v47
    v_cvt_pk_bf16_f32 v47, v47, v47
    v_lshlrev_b32 v47, 16, v47
    v_add_f32 v223, v223, v47
    v_cvt_pk_bf16_f32 v223, v223, v223
    v_lshlrev_b32 v223, 16, v223
K3_NOMOE0:
    s_mov_b64 exec, s[62:63]
    v_cmp_eq_u32 vcc, s49, v8
    s_and_saveexec_b64 s[62:63], vcc
    s_cbranch_execz K3_NOMOE1
    s_lshl_b32 s60, s21, 8
    s_lshl_b32 s61, s19, 7
    s_add_u32 s60, s60, s61
    v_lshlrev_b32 v13, 4, v10
    v_add_u32 v13, s60, v13
    v_add_u32 v13, 7342080, v13
    buffer_load_dwordx4 v[32:35], v13, s[36:39], 0 offen offset:0
    buffer_load_dwordx4 v[36:39], v13, s[36:39], 0 offen offset:32
    buffer_load_dwordx4 v[40:43], v13, s[36:39], 0 offen offset:64
    buffer_load_dwordx4 v[44:47], v13, s[36:39], 0 offen offset:96
    s_waitcnt vmcnt(0)
    v_cvt_pk_bf16_f32 v32, v32, v32
    v_lshlrev_b32 v32, 16, v32
    v_mul_f32 v32, s51, v32
    v_cvt_pk_bf16_f32 v32, v32, v32
    v_lshlrev_b32 v32, 16, v32
    v_add_f32 v208, v208, v32
    v_cvt_pk_bf16_f32 v208, v208, v208
    v_lshlrev_b32 v208, 16, v208
    v_cvt_pk_bf16_f32 v33, v33, v33
    v_lshlrev_b32 v33, 16, v33
    v_mul_f32 v33, s51, v33
    v_cvt_pk_bf16_f32 v33, v33, v33
    v_lshlrev_b32 v33, 16, v33
    v_add_f32 v209, v209, v33
    v_cvt_pk_bf16_f32 v209, v209, v209
    v_lshlrev_b32 v209, 16, v209
    v_cvt_pk_bf16_f32 v34, v34, v34
    v_lshlrev_b32 v34, 16, v34
    v_mul_f32 v34, s51, v34
    v_cvt_pk_bf16_f32 v34, v34, v34
    v_lshlrev_b32 v34, 16, v34
    v_add_f32 v210, v210, v34
    v_cvt_pk_bf16_f32 v210, v210, v210
    v_lshlrev_b32 v210, 16, v210
    v_cvt_pk_bf16_f32 v35, v35, v35
    v_lshlrev_b32 v35, 16, v35
    v_mul_f32 v35, s51, v35
    v_cvt_pk_bf16_f32 v35, v35, v35
    v_lshlrev_b32 v35, 16, v35
    v_add_f32 v211, v211, v35
    v_cvt_pk_bf16_f32 v211, v211, v211
    v_lshlrev_b32 v211, 16, v211
    v_cvt_pk_bf16_f32 v36, v36, v36
    v_lshlrev_b32 v36, 16, v36
    v_mul_f32 v36, s51, v36
    v_cvt_pk_bf16_f32 v36, v36, v36
    v_lshlrev_b32 v36, 16, v36
    v_add_f32 v212, v212, v36
    v_cvt_pk_bf16_f32 v212, v212, v212
    v_lshlrev_b32 v212, 16, v212
    v_cvt_pk_bf16_f32 v37, v37, v37
    v_lshlrev_b32 v37, 16, v37
    v_mul_f32 v37, s51, v37
    v_cvt_pk_bf16_f32 v37, v37, v37
    v_lshlrev_b32 v37, 16, v37
    v_add_f32 v213, v213, v37
    v_cvt_pk_bf16_f32 v213, v213, v213
    v_lshlrev_b32 v213, 16, v213
    v_cvt_pk_bf16_f32 v38, v38, v38
    v_lshlrev_b32 v38, 16, v38
    v_mul_f32 v38, s51, v38
    v_cvt_pk_bf16_f32 v38, v38, v38
    v_lshlrev_b32 v38, 16, v38
    v_add_f32 v214, v214, v38
    v_cvt_pk_bf16_f32 v214, v214, v214
    v_lshlrev_b32 v214, 16, v214
    v_cvt_pk_bf16_f32 v39, v39, v39
    v_lshlrev_b32 v39, 16, v39
    v_mul_f32 v39, s51, v39
    v_cvt_pk_bf16_f32 v39, v39, v39
    v_lshlrev_b32 v39, 16, v39
    v_add_f32 v215, v215, v39
    v_cvt_pk_bf16_f32 v215, v215, v215
    v_lshlrev_b32 v215, 16, v215
    v_cvt_pk_bf16_f32 v40, v40, v40
    v_lshlrev_b32 v40, 16, v40
    v_mul_f32 v40, s51, v40
    v_cvt_pk_bf16_f32 v40, v40, v40
    v_lshlrev_b32 v40, 16, v40
    v_add_f32 v216, v216, v40
    v_cvt_pk_bf16_f32 v216, v216, v216
    v_lshlrev_b32 v216, 16, v216
    v_cvt_pk_bf16_f32 v41, v41, v41
    v_lshlrev_b32 v41, 16, v41
    v_mul_f32 v41, s51, v41
    v_cvt_pk_bf16_f32 v41, v41, v41
    v_lshlrev_b32 v41, 16, v41
    v_add_f32 v217, v217, v41
    v_cvt_pk_bf16_f32 v217, v217, v217
    v_lshlrev_b32 v217, 16, v217
    v_cvt_pk_bf16_f32 v42, v42, v42
    v_lshlrev_b32 v42, 16, v42
    v_mul_f32 v42, s51, v42
    v_cvt_pk_bf16_f32 v42, v42, v42
    v_lshlrev_b32 v42, 16, v42
    v_add_f32 v218, v218, v42
    v_cvt_pk_bf16_f32 v218, v218, v218
    v_lshlrev_b32 v218, 16, v218
    v_cvt_pk_bf16_f32 v43, v43, v43
    v_lshlrev_b32 v43, 16, v43
    v_mul_f32 v43, s51, v43
    v_cvt_pk_bf16_f32 v43, v43, v43
    v_lshlrev_b32 v43, 16, v43
    v_add_f32 v219, v219, v43
    v_cvt_pk_bf16_f32 v219, v219, v219
    v_lshlrev_b32 v219, 16, v219
    v_cvt_pk_bf16_f32 v44, v44, v44
    v_lshlrev_b32 v44, 16, v44
    v_mul_f32 v44, s51, v44
    v_cvt_pk_bf16_f32 v44, v44, v44
    v_lshlrev_b32 v44, 16, v44
    v_add_f32 v220, v220, v44
    v_cvt_pk_bf16_f32 v220, v220, v220
    v_lshlrev_b32 v220, 16, v220
    v_cvt_pk_bf16_f32 v45, v45, v45
    v_lshlrev_b32 v45, 16, v45
    v_mul_f32 v45, s51, v45
    v_cvt_pk_bf16_f32 v45, v45, v45
    v_lshlrev_b32 v45, 16, v45
    v_add_f32 v221, v221, v45
    v_cvt_pk_bf16_f32 v221, v221, v221
    v_lshlrev_b32 v221, 16, v221
    v_cvt_pk_bf16_f32 v46, v46, v46
    v_lshlrev_b32 v46, 16, v46
    v_mul_f32 v46, s51, v46
    v_cvt_pk_bf16_f32 v46, v46, v46
    v_lshlrev_b32 v46, 16, v46
    v_add_f32 v222, v222, v46
    v_cvt_pk_bf16_f32 v222, v222, v222
    v_lshlrev_b32 v222, 16, v222
    v_cvt_pk_bf16_f32 v47, v47, v47
    v_lshlrev_b32 v47, 16, v47
    v_mul_f32 v47, s51, v47
    v_cvt_pk_bf16_f32 v47, v47, v47
    v_lshlrev_b32 v47, 16, v47
    v_add_f32 v223, v223, v47
    v_cvt_pk_bf16_f32 v223, v223, v223
    v_lshlrev_b32 v223, 16, v223
K3_NOMOE1:
    s_mov_b64 exec, s[62:63]
    v_cvt_pk_bf16_f32 v13, v16, v17
    v_lshlrev_b32 v16, 16, v13
    v_and_b32 v17, 0xffff0000, v13
    v_lshlrev_b32 v13, 16, v192
    v_add_f32 v16, v16, v13
    v_and_b32 v13, 0xffff0000, v192
    v_add_f32 v17, v17, v13
    v_cvt_pk_bf16_f32 v13, v16, v17
    v_lshlrev_b32 v16, 16, v13
    v_and_b32 v17, 0xffff0000, v13
    v_add_f32 v16, v16, v208
    v_add_f32 v17, v17, v209
    v_cvt_pk_bf16_f32 v32, v16, v17
    v_cvt_pk_bf16_f32 v13, v18, v19
    v_lshlrev_b32 v18, 16, v13
    v_and_b32 v19, 0xffff0000, v13
    v_lshlrev_b32 v13, 16, v193
    v_add_f32 v18, v18, v13
    v_and_b32 v13, 0xffff0000, v193
    v_add_f32 v19, v19, v13
    v_cvt_pk_bf16_f32 v13, v18, v19
    v_lshlrev_b32 v18, 16, v13
    v_and_b32 v19, 0xffff0000, v13
    v_add_f32 v18, v18, v210
    v_add_f32 v19, v19, v211
    v_cvt_pk_bf16_f32 v33, v18, v19
    buffer_store_dwordx2 v[32:33], v12, s[32:35], 0 offen offset:0
    v_cvt_pk_bf16_f32 v13, v20, v21
    v_lshlrev_b32 v20, 16, v13
    v_and_b32 v21, 0xffff0000, v13
    v_lshlrev_b32 v13, 16, v194
    v_add_f32 v20, v20, v13
    v_and_b32 v13, 0xffff0000, v194
    v_add_f32 v21, v21, v13
    v_cvt_pk_bf16_f32 v13, v20, v21
    v_lshlrev_b32 v20, 16, v13
    v_and_b32 v21, 0xffff0000, v13
    v_add_f32 v20, v20, v212
    v_add_f32 v21, v21, v213
    v_cvt_pk_bf16_f32 v34, v20, v21
    v_cvt_pk_bf16_f32 v13, v22, v23
    v_lshlrev_b32 v22, 16, v13
    v_and_b32 v23, 0xffff0000, v13
    v_lshlrev_b32 v13, 16, v195
    v_add_f32 v22, v22, v13
    v_and_b32 v13, 0xffff0000, v195
    v_add_f32 v23, v23, v13
    v_cvt_pk_bf16_f32 v13, v22, v23
    v_lshlrev_b32 v22, 16, v13
    v_and_b32 v23, 0xffff0000, v13
    v_add_f32 v22, v22, v214
    v_add_f32 v23, v23, v215
    v_cvt_pk_bf16_f32 v35, v22, v23
    buffer_store_dwordx2 v[34:35], v12, s[32:35], 0 offen offset:16
    v_cvt_pk_bf16_f32 v13, v24, v25
    v_lshlrev_b32 v24, 16, v13
    v_and_b32 v25, 0xffff0000, v13
    v_lshlrev_b32 v13, 16, v196
    v_add_f32 v24, v24, v13
    v_and_b32 v13, 0xffff0000, v196
    v_add_f32 v25, v25, v13
    v_cvt_pk_bf16_f32 v13, v24, v25
    v_lshlrev_b32 v24, 16, v13
    v_and_b32 v25, 0xffff0000, v13
    v_add_f32 v24, v24, v216
    v_add_f32 v25, v25, v217
    v_cvt_pk_bf16_f32 v36, v24, v25
    v_cvt_pk_bf16_f32 v13, v26, v27
    v_lshlrev_b32 v26, 16, v13
    v_and_b32 v27, 0xffff0000, v13
    v_lshlrev_b32 v13, 16, v197
    v_add_f32 v26, v26, v13
    v_and_b32 v13, 0xffff0000, v197
    v_add_f32 v27, v27, v13
    v_cvt_pk_bf16_f32 v13, v26, v27
    v_lshlrev_b32 v26, 16, v13
    v_and_b32 v27, 0xffff0000, v13
    v_add_f32 v26, v26, v218
    v_add_f32 v27, v27, v219
    v_cvt_pk_bf16_f32 v37, v26, v27
    buffer_store_dwordx2 v[36:37], v12, s[32:35], 0 offen offset:32
    v_cvt_pk_bf16_f32 v13, v28, v29
    v_lshlrev_b32 v28, 16, v13
    v_and_b32 v29, 0xffff0000, v13
    v_lshlrev_b32 v13, 16, v198
    v_add_f32 v28, v28, v13
    v_and_b32 v13, 0xffff0000, v198
    v_add_f32 v29, v29, v13
    v_cvt_pk_bf16_f32 v13, v28, v29
    v_lshlrev_b32 v28, 16, v13
    v_and_b32 v29, 0xffff0000, v13
    v_add_f32 v28, v28, v220
    v_add_f32 v29, v29, v221
    v_cvt_pk_bf16_f32 v38, v28, v29
    v_cvt_pk_bf16_f32 v13, v30, v31
    v_lshlrev_b32 v30, 16, v13
    v_and_b32 v31, 0xffff0000, v13
    v_lshlrev_b32 v13, 16, v199
    v_add_f32 v30, v30, v13
    v_and_b32 v13, 0xffff0000, v199
    v_add_f32 v31, v31, v13
    v_cvt_pk_bf16_f32 v13, v30, v31
    v_lshlrev_b32 v30, 16, v13
    v_and_b32 v31, 0xffff0000, v13
    v_add_f32 v30, v30, v222
    v_add_f32 v31, v31, v223
    v_cvt_pk_bf16_f32 v39, v30, v31
    buffer_store_dwordx2 v[38:39], v12, s[32:35], 0 offen offset:48
K3_END:
    s_endpgm
.section .rodata,"a"
.p2align 6
.amdhsa_kernel prep_kernel
  .amdhsa_next_free_vgpr 192
  .amdhsa_next_free_sgpr 102
  .amdhsa_accum_offset 192
  .amdhsa_group_segment_fixed_size 0
  .amdhsa_kernarg_size 104
  .amdhsa_user_sgpr_count 2
  .amdhsa_user_sgpr_kernarg_segment_ptr 1
  .amdhsa_system_sgpr_workgroup_id_x 1
.end_amdhsa_kernel
.text
.section .rodata,"a"
.p2align 6
.amdhsa_kernel attn_kernel
  .amdhsa_next_free_vgpr 128
  .amdhsa_next_free_sgpr 102
  .amdhsa_accum_offset 128
  .amdhsa_group_segment_fixed_size 0
  .amdhsa_kernarg_size 104
  .amdhsa_user_sgpr_count 2
  .amdhsa_user_sgpr_kernarg_segment_ptr 1
  .amdhsa_system_sgpr_workgroup_id_x 1
.end_amdhsa_kernel
.text
.section .rodata,"a"
.p2align 6
.amdhsa_kernel out_kernel
  .amdhsa_next_free_vgpr 224
  .amdhsa_next_free_sgpr 102
  .amdhsa_accum_offset 224
  .amdhsa_group_segment_fixed_size 0
  .amdhsa_kernarg_size 104
  .amdhsa_user_sgpr_count 2
  .amdhsa_user_sgpr_kernarg_segment_ptr 1
  .amdhsa_system_sgpr_workgroup_id_x 1
.end_amdhsa_kernel
.text
```
